```python
import torch

def _softmax(x, axis=-1):
    return torch.softmax(x, dim=axis)
def _gelu(x):
    return torch.nn.functional.gelu(x, approximate="tanh")
def _silu(x):
    return torch.nn.functional.silu(x)
def _sigmoid(x):
    return torch.sigmoid(x)
def _layernorm(x, axis=-1, eps=1e-5):
    m = x.mean(dim=axis, keepdim=True)
    v = x.var(dim=axis, keepdim=True, unbiased=False)
    return (x - m) / torch.sqrt(v + eps)
def _scatter_add(tgt, idx, src, axis=0):
    return tgt.clone().index_add_(axis, idx, src)
def _segment_sum(src, seg, n):
    out = torch.zeros((n,) + src.shape[1:], dtype=src.dtype)
    return out.index_add_(0, seg, src)
def _pad(x, pw):
    flat = tuple(v for pair in reversed(pw) for v in pair)
    return torch.nn.functional.pad(x, flat)

kernel_name = 'standalone__deep_cross_xdeepfm__recsys'

def setup_inputs():

    _w = (lambda a: (lambda t: t.to(torch.bfloat16) if t.is_floating_point() else t)(torch.as_tensor(a)))
    B, F, D, L = 4096, 26, 16, 6
    V = min(1000, 100000)
    Din = F * D
    return {
        "idx": _w((lambda lo, hi, *s: torch.randint(lo, hi, s))(0, V, B, F).to(torch.int64)),
        "table": _w((lambda *s: torch.randn(*s, dtype=torch.bfloat16) * 0.8)(V, D)),
        "ws_cin": _w((lambda *s: torch.randn(*s, dtype=torch.bfloat16) * 0.4)(L, F, F, F) * (1.0 / F)),
        "w_cin_out": _w((lambda *s: torch.randn(*s, dtype=torch.bfloat16) * 0.4)(L * F) * ((L * F) ** -0.5)),
        "w_dnn1": _w((lambda *s: torch.randn(*s, dtype=torch.bfloat16) * 0.8)(Din, Din) * (Din ** -0.5)),
        "b_dnn1": _w((lambda *s: torch.randn(*s, dtype=torch.bfloat16) * 3.2)(Din) * 0.1),
        "w_dnn2": _w((lambda *s: torch.randn(*s, dtype=torch.bfloat16) * 0.4)(Din) * (Din ** -0.5)),
        "b_out": _w((lambda *s: torch.randn(*s, dtype=torch.bfloat16) * 0.4)(1)),
    }

def reference(idx, table, ws_cin, w_cin_out, w_dnn1, b_dnn1, w_dnn2, b_out):
    x0 = table[idx]
    B = x0.shape[0]
    L = ws_cin.shape[0]
    xk = x0
    pooled = []
    for l in range(L):
        xk = torch.einsum('bid,bjd,hij->bhd', xk, x0, ws_cin[l])
        pooled.append(xk.sum(axis=-1))
    p_plus = torch.stack(pooled, axis=1).reshape(B, -1)
    logit_cin = p_plus @ w_cin_out
    h = x0.reshape(B, -1)
    h = _gelu(h @ w_dnn1 + b_dnn1)
    logit_dnn = h @ w_dnn2
    return logit_cin + logit_dnn + b_out
```

```asm
; @launch grid=(256,1,1) block=(576,1,1) lds=163776
.amdgcn_target "amdgcn-amd-amdhsa--gfx950"
.text
.globl standalone__deep_cross_xdeepfm__recsys_kernel
.p2align 8
.type standalone__deep_cross_xdeepfm__recsys_kernel,@function
standalone__deep_cross_xdeepfm__recsys_kernel:
    s_cmp_ge_u32 s2, 256
    s_cbranch_scc1 L_end
    s_load_dwordx16 s[4:19], s[0:1], 0
    s_load_dwordx4 s[20:23], s[0:1], 64
    s_load_dwordx2 s[64:65], s[0:1], 80
    v_and_b32 v1, 63, v0
    v_lshrrev_b32 v2, 6, v0
    s_nop 0
    v_readfirstlane_b32 s68, v2
    v_lshlrev_b32 v3, 2, v1
    v_add_u32 v3, 163712, v3
    v_mov_b32 v4, 0
    s_cmp_lg_u32 s68, 0
    s_cbranch_scc1 L_noinit
    s_mov_b64 exec, 0xffff
    ds_write_b32 v3, v4
    s_mov_b64 exec, -1
L_noinit:
    s_mov_b32 s77, 0x7fff7fff
    s_mov_b32 s78, 0x80008000
    s_mov_b32 s82, 0x38003800
    s_mov_b32 s74, 0
    s_mov_b32 s75, -1
    v_lshlrev_b32 v31, 4, v1
    s_lshr_b32 s69, s2, 3
    s_and_b32 s79, s69, 3
    s_lshr_b32 s70, s69, 2
    s_lshr_b32 s83, s70, 1
    s_add_u32 s83, s83, s70
    s_andn2_b32 s87, s2, 0x18
    s_mov_b32 s92, 0
    s_and_b32 s70, s2, 7
    s_lshl_b32 s86, s70, 5
    s_add_u32 s86, s86, s69
    s_cmp_ge_u32 s68, 4
    s_cselect_b32 s86, 255, s86
    s_cmp_eq_u32 s68, 8
    s_cselect_b32 s86, 255, s86
    s_and_b32 s81, s68, 3
    s_lshl_b32 s70, s86, 2
    s_add_u32 s81, s81, s70
    s_min_u32 s89, s79, 1
    s_mul_i32 s70, s79, 6
    s_add_u32 s89, s89, s70
    s_cmp_lt_u32 s68, 4
    s_cselect_b32 s88, 1, 0
    s_cmp_lt_u32 s79, 2
    s_cselect_b32 s88, s88, 0
    s_waitcnt lgkmcnt(0)
    s_barrier
    s_mov_b32 s24, s4
    s_and_b32 s25, s5, 0xffff
    s_mov_b32 s26, 425984
    s_mov_b32 s27, 0x00020000
    s_mov_b32 s28, s6
    s_and_b32 s29, s7, 0xffff
    s_mov_b32 s30, 32000
    s_mov_b32 s31, 0x00020000
    s_mov_b32 s32, s8
    s_and_b32 s33, s9, 0xffff
    s_mov_b32 s34, 210912
    s_mov_b32 s35, 0x00020000
    s_mov_b32 s36, s10
    s_and_b32 s37, s11, 0xffff
    s_mov_b32 s38, 312
    s_mov_b32 s39, 0x00020000
    s_mov_b32 s40, s12
    s_and_b32 s41, s13, 0xffff
    s_mov_b32 s42, 346112
    s_mov_b32 s43, 0x00020000
    s_mov_b32 s44, s14
    s_and_b32 s45, s15, 0xffff
    s_mov_b32 s46, 832
    s_mov_b32 s47, 0x00020000
    s_mov_b32 s48, s16
    s_and_b32 s49, s17, 0xffff
    s_mov_b32 s50, 832
    s_mov_b32 s51, 0x00020000
    s_mov_b32 s52, s18
    s_and_b32 s53, s19, 0xffff
    s_mov_b32 s54, 2
    s_mov_b32 s55, 0x00020000
    s_mov_b32 s56, s20
    s_and_b32 s57, s21, 0xffff
    s_mov_b32 s58, 8192
    s_mov_b32 s59, 0x00020000
    s_mov_b32 s60, s22
    s_and_b32 s61, s23, 0xffff
    s_mov_b32 s62, 256
    s_mov_b32 s63, 0x00020000
    s_and_b32 s65, s65, 0xffff
    s_mov_b32 s66, 524288
    s_mov_b32 s67, 0x00020000
    s_cmp_eq_u32 s68, 8
    s_cbranch_scc1 L_loader
    v_mov_b32 v165, 163712
    s_lshl_b32 s69, s68, 12
    s_add_u32 m0, s69, 71680
    s_nop 0
    buffer_load_dwordx4 v31, s[28:31], s69 offen offset:0 lds
    buffer_load_dwordx4 v31, s[28:31], s69 offen offset:1024 lds
    buffer_load_dwordx4 v31, s[28:31], s69 offen offset:2048 lds
    s_cmp_eq_u32 s68, 7
    s_cselect_b64 exec, 0xffff, -1
    buffer_load_dwordx4 v31, s[28:31], s69 offen offset:3072 lds
    s_lshr_b32 s69, s68, 1
    s_add_u32 s69, s69, s79
    s_and_b32 s69, s69, 3
    s_lshl_b32 s69, s69, 3
    s_or_b32 s69, s69, s87
    s_lshl_b32 s69, s69, 1
    s_and_b32 s70, s68, 1
    s_add_u32 s69, s69, s70
    s_mul_i32 s69, s69, 832
    s_mul_i32 s70, s68, 832
    s_add_u32 m0, s70, 103680
    s_mov_b32 exec_lo, -1
    s_mov_b32 exec_hi, 0xfffff
    buffer_load_dwordx4 v31, s[24:27], s69 offen lds
    s_cmp_lg_u32 s68, 5
    s_cbranch_scc1 L_nb1
    s_mov_b32 m0, 162048
    s_nop 0
    buffer_load_dwordx4 v31, s[44:47], 0 offen lds
    s_mov_b32 m0, 162880
    s_nop 0
    buffer_load_dwordx4 v31, s[48:51], 0 offen lds
L_nb1:
    s_mov_b64 exec, -1
    v_mov_b32 v137, 0x7f000000
    v_lshrrev_b32 v2, 4, v0
    v_and_b32 v3, 15, v0
    v_mad_u32_u24 v2, v2, 13, v3
    v_lshlrev_b32 v2, 1, v2
    v_cmp_gt_u32 vcc, 13, v3
    s_nop 1
    v_cndmask_b32 v2, v137, v2, vcc
    s_cmp_gt_u32 s68, 2
    s_cbranch_scc1 L_nopw
    buffer_load_ushort v136, v2, s[36:39], 0 offen
L_nopw:
    v_mov_b32 v4, 0
    buffer_load_ushort v15, v4, s[52:55], 0 offen
    s_cmp_ge_u32 s86, 31
    s_cbranch_scc1 L_noprod
    s_cmp_ge_u32 s81, 68
    s_cbranch_scc1 L_prodv5
    s_cmp_ge_u32 s81, 67
    s_cbranch_scc1 L_noprod
    s_cmp_ge_u32 s81, 28
    s_cbranch_scc1 L_prodrow
    s_cmp_ge_u32 s81, 26
    s_cbranch_scc1 L_noprod
    v_and_b32 v72, 31, v1
    v_lshrrev_b32 v73, 5, v1
    v_mul_u32_u24 v74, 52, v72
    v_lshl_add_u32 v74, v73, 4, v74
    s_mul_i32 s71, s81, 1352
    buffer_load_dwordx4 v[116:119], v74, s[32:35], s71 offen
    buffer_load_dwordx4 v[120:123], v74, s[32:35], s71 offen offset:32
    v_lshlrev_b32 v75, 3, v73
    v_sub_u32 v75, v72, v75
    v_and_b32 v76, 1, v75
    v_lshlrev_b32 v76, 4, v76
    v_mov_b32 v77, 0x3f80
    v_lshlrev_b32 v76, v76, v77
    v_ashrrev_i32 v75, 1, v75
    v_cmp_eq_u32 vcc, 0, v75
    s_nop 1
    v_cndmask_b32 v124, 0, v76, vcc
    v_cmp_eq_u32 vcc, 1, v75
    s_nop 1
    v_cndmask_b32 v125, 0, v76, vcc
    v_cmp_eq_u32 vcc, 2, v75
    s_nop 1
    v_cndmask_b32 v126, 0, v76, vcc
    v_cmp_eq_u32 vcc, 3, v75
    s_nop 1
    v_cndmask_b32 v127, 0, v76, vcc
    v_cmp_eq_u32 vcc, 8, v75
    s_nop 1
    v_cndmask_b32 v128, 0, v76, vcc
    v_cmp_eq_u32 vcc, 9, v75
    s_nop 1
    v_cndmask_b32 v129, 0, v76, vcc
    v_cmp_eq_u32 vcc, 10, v75
    s_nop 1
    v_cndmask_b32 v130, 0, v76, vcc
    v_cmp_eq_u32 vcc, 11, v75
    s_nop 1
    v_cndmask_b32 v131, 0, v76, vcc
    s_lshl_b32 s72, s68, 10
    s_add_u32 s72, s72, 110336
    v_lshrrev_b32 v75, 1, v72
    v_and_b32 v76, 1, v72
    v_subrev_u32 v77, 1, v75
    v_mul_i32_i24 v77, v77, v75
    v_lshrrev_b32 v77, 1, v77
    v_mul_u32_u24 v78, 12, v75
    v_sub_u32 v78, v78, v77
    v_mul_u32_u24 v77, 92, v76
    v_add_u32 v78, v78, v77
    v_lshl_add_u32 v78, v73, 1, v78
    v_lshlrev_b32 v78, 2, v78
    v_add_u32 v78, s72, v78
    v_lshlrev_b32 v77, 1, v73
    v_sub_u32 v75, v75, v77
    v_cmp_gt_u32 vcc, 26, v72
    v_mov_b32 v77, 100
    s_nop 0
    v_cndmask_b32 v75, v77, v75, vcc
    v_add_u32 v80, s72, v31
    v_cmp_le_u32 vcc, 23, v1
    s_nop 1
    v_cndmask_b32 v81, 0, 1, vcc
    s_mov_b32 s69, s81
    s_cmp_ge_u32 s69, 13
    s_cselect_b32 s70, 1, 0
    s_mul_i32 s73, s70, 13
    s_sub_u32 s69, s69, s73
    s_lshl_b32 s73, s70, 2
    s_lshl_b32 s70, s70, 4
    s_add_u32 s70, s70, s69
    s_add_u32 s73, s73, s69
    s_and_b32 s69, s69, 12
    s_add_u32 s69, s69, s73
    s_add_u32 s69, s69, 1
    s_cmp_eq_u32 s69, 29
    s_cselect_b32 s69, 0, s69
    v_mul_u32_u24 v81, 9200, v81
    v_add_u32 v81, v81, v31
    s_mul_i32 s69, s69, 368
    s_add_u32 s69, s69, 0
    s_waitcnt vmcnt(0)
    s_setprio 3
    v_mov_b32 v3, 1
    s_mov_b64 exec, 1
    ds_add_u32 v165, v3 offset:24
    s_mov_b64 exec, -1
    s_waitcnt vmcnt(0)
    v_mfma_f32_32x32x16_bf16 v[40:55], v[116:119], v[124:127], 0
    s_waitcnt vmcnt(0)
    v_mfma_f32_32x32x16_bf16 v[40:55], v[120:123], v[128:131], v[40:55]
    v_mfma_f32_32x32x16_bf16 v[40:55], v[124:127], v[116:119], v[40:55]
    v_mfma_f32_32x32x16_bf16 v[40:55], v[128:131], v[120:123], v[40:55]
    s_nop 11
    v_max3_f32 v82, |v40|, |v41|, |v42|
    v_max3_f32 v82, |v43|, |v44|, v82
    v_max3_f32 v82, |v45|, |v46|, v82
    v_max3_f32 v82, |v47|, |v48|, v82
    v_max3_f32 v82, |v49|, |v50|, v82
    v_max3_f32 v82, |v51|, |v52|, v82
    v_max3_f32 v82, |v53|, |v54|, v82
    s_nop 1
    v_max_u32_dpp v82, v82, v82 row_shr:1 row_mask:0xf bank_mask:0xf
    s_nop 1
    v_max_u32_dpp v82, v82, v82 row_shr:2 row_mask:0xf bank_mask:0xf
    s_nop 1
    v_max_u32_dpp v82, v82, v82 row_shr:4 row_mask:0xf bank_mask:0xf
    s_nop 1
    v_max_u32_dpp v82, v82, v82 row_shr:8 row_mask:0xf bank_mask:0xf
    s_nop 1
    v_max_u32_dpp v82, v82, v82 row_bcast:15 row_mask:0xa bank_mask:0xf
    s_nop 1
    v_max_u32_dpp v82, v82, v82 row_bcast:31 row_mask:0xc bank_mask:0xf
    v_frexp_exp_i32_f32 v82, v82
    s_nop 0
    v_readlane_b32 s73, v82, 63
    s_nop 0
    s_sub_i32 s76, 15, s73
    s_sub_i32 s73, s73, 15
    v_ldexp_f32 v40, v40, s76
    v_ldexp_f32 v41, v41, s76
    v_ldexp_f32 v42, v42, s76
    v_ldexp_f32 v43, v43, s76
    v_ldexp_f32 v44, v44, s76
    v_ldexp_f32 v45, v45, s76
    v_ldexp_f32 v46, v46, s76
    v_ldexp_f32 v47, v47, s76
    v_ldexp_f32 v48, v48, s76
    v_ldexp_f32 v49, v49, s76
    v_ldexp_f32 v50, v50, s76
    v_ldexp_f32 v51, v51, s76
    v_ldexp_f32 v52, v52, s76
    v_ldexp_f32 v53, v53, s76
    v_cvt_pk_f16_f32 v116, v40, v41
    v_cvt_pk_f16_f32 v117, v42, v43
    v_cvt_pk_f16_f32 v118, v44, v45
    v_cvt_pk_f16_f32 v119, v46, v47
    v_cvt_pk_f16_f32 v120, v48, v49
    v_cvt_pk_f16_f32 v121, v50, v51
    v_cvt_pk_f16_f32 v122, v52, v53
    v_mov_b32 v79, 0
    v_mov_b32 v85, s72
    ds_write_b32 v85, v79 offset:364
    ds_write_b32 v85, v79 offset:732
    v_cmp_ge_i32 vcc, 0, v75
    s_nop 0
    s_mov_b64 exec, vcc
    ds_write_b32 v78, v116 offset:0
    s_mov_b64 exec, -1
    v_cmp_ge_i32 vcc, 1, v75
    s_nop 0
    s_mov_b64 exec, vcc
    ds_write_b32 v78, v117 offset:4
    s_mov_b64 exec, -1
    v_cmp_ge_i32 vcc, 4, v75
    s_nop 0
    s_mov_b64 exec, vcc
    ds_write_b32 v78, v118 offset:16
    s_mov_b64 exec, -1
    v_cmp_ge_i32 vcc, 5, v75
    s_nop 0
    s_mov_b64 exec, vcc
    ds_write_b32 v78, v119 offset:20
    s_mov_b64 exec, -1
    v_cmp_ge_i32 vcc, 8, v75
    s_nop 0
    s_mov_b64 exec, vcc
    ds_write_b32 v78, v120 offset:32
    s_mov_b64 exec, -1
    v_cmp_ge_i32 vcc, 9, v75
    s_nop 0
    s_mov_b64 exec, vcc
    ds_write_b32 v78, v121 offset:36
    s_mov_b64 exec, -1
    v_cmp_ge_i32 vcc, 12, v75
    s_nop 0
    s_mov_b32 vcc_hi, 0
    s_mov_b64 exec, vcc
    ds_write_b32 v78, v122 offset:48
    s_mov_b64 exec, -1
    s_waitcnt lgkmcnt(0)
    ds_read_b128 v[124:127], v80
    s_mov_b32 exec_hi, 0x3fff
    s_waitcnt lgkmcnt(0)
    buffer_store_dwordx4 v[124:127], v81, s[64:67], s69 offen sc1
    s_mov_b64 exec, -1
    s_lshl_b32 s70, s70, 2
    s_add_u32 s70, s70, 166400
    v_mov_b32 v83, s73
    v_mov_b32 v84, s70
    s_mov_b64 exec, 1
    buffer_store_dword v83, v84, s[64:67], 0 offen sc1
    s_branch L_prodfin
L_prodrow:
    s_sub_u32 s81, s81, 28
    s_lshl_b32 s81, s81, 1
    s_mul_i32 s71, s81, 1352
    s_add_u32 s71, s71, 35152
    v_cmp_le_u32 vcc, 43, v1
    s_nop 1
    v_cndmask_b32 v72, 0, 1, vcc
    v_mul_u32_u24 v74, 12, v72
    v_sub_u32 v74, v31, v74
    v_min_u32 v75, 21, v1
    v_lshlrev_b32 v76, 4, v75
    buffer_load_dwordx4 v[40:43], v74, s[32:35], s71 offen offset:0
    buffer_load_dwordx4 v[44:47], v76, s[32:35], s71 offen offset:1012
    buffer_load_dwordx4 v[48:51], v74, s[32:35], s71 offen offset:1352
    buffer_load_dwordx4 v[52:55], v76, s[32:35], s71 offen offset:2364
    v_mul_u32_u24 v79, 17200, v72
    v_add_u32 v79, v79, v31
    v_add_u32 v80, 18224, v76
    s_mul_i32 s70, s81, 2521
    s_lshr_b32 s70, s70, 16
    s_mul_i32 s72, s70, 26
    s_sub_u32 s69, s81, s72
    s_add_u32 s69, s69, 0
    s_cmp_ge_u32 s69, 13
    s_cselect_b32 s72, 1, 0
    s_mul_i32 s73, s72, 13
    s_sub_u32 s69, s69, s73
    s_lshl_b32 s73, s72, 2
    s_lshl_b32 s72, s72, 4
    s_add_u32 s72, s72, s69
    s_add_u32 s73, s73, s69
    s_and_b32 s69, s69, 12
    s_add_u32 s69, s69, s73
    s_add_u32 s69, s69, 1
    s_cmp_eq_u32 s69, 29
    s_cselect_b32 s69, 0, s69
    s_mul_i32 s69, s69, 688
    s_mul_i32 s4, s70, 35776
    s_add_u32 s4, s4, s69
    s_add_u32 s4, s4, 19200
    s_lshl_b32 s5, s70, 5
    s_add_u32 s5, s5, s72
    s_lshl_b32 s5, s5, 2
    s_add_u32 s5, s5, 166528
    s_mul_i32 s72, s70, 26
    s_sub_u32 s69, s81, s72
    s_add_u32 s69, s69, 1
    s_cmp_ge_u32 s69, 13
    s_cselect_b32 s72, 1, 0
    s_mul_i32 s73, s72, 13
    s_sub_u32 s69, s69, s73
    s_lshl_b32 s73, s72, 2
    s_lshl_b32 s72, s72, 4
    s_add_u32 s72, s72, s69
    s_add_u32 s73, s73, s69
    s_and_b32 s69, s69, 12
    s_add_u32 s69, s69, s73
    s_add_u32 s69, s69, 1
    s_cmp_eq_u32 s69, 29
    s_cselect_b32 s69, 0, s69
    s_mul_i32 s69, s69, 688
    s_mul_i32 s6, s70, 35776
    s_add_u32 s6, s6, s69
    s_add_u32 s6, s6, 19200
    s_lshl_b32 s7, s70, 5
    s_add_u32 s7, s7, s72
    s_lshl_b32 s7, s7, 2
    s_add_u32 s7, s7, 166528
    s_waitcnt vmcnt(0)
    s_setprio 3
    v_mov_b32 v3, 1
    s_mov_b64 exec, 1
    ds_add_u32 v165, v3 offset:24
    s_mov_b64 exec, -1
    s_waitcnt vmcnt(0)
    v_and_b32 v88, s77, v40
    v_and_b32 v89, s77, v41
    v_and_b32 v90, s77, v42
    v_and_b32 v91, s77, v43
    s_waitcnt vmcnt(0)
    v_and_b32 v92, s77, v44
    v_and_b32 v93, s77, v45
    v_and_b32 v94, s77, v46
    v_and_b32 v95, s77, v47
    s_waitcnt vmcnt(0)
    v_and_b32 v96, s77, v48
    v_and_b32 v97, s77, v49
    v_and_b32 v98, s77, v50
    v_and_b32 v99, s77, v51
    s_waitcnt vmcnt(0)
    v_and_b32 v100, s77, v52
    v_and_b32 v101, s77, v53
    v_and_b32 v102, s77, v54
    v_and_b32 v103, s77, v55
    v_pk_max_u16 v83, v88, v89
    v_pk_maximum3_f16 v83, v83, v90, v91
    v_pk_maximum3_f16 v83, v83, v92, v93
    v_pk_maximum3_f16 v83, v83, v94, v95
    v_pk_maximum3_f16 v83, v83, v96, v97
    v_pk_maximum3_f16 v83, v83, v98, v99
    v_pk_maximum3_f16 v83, v83, v100, v101
    v_pk_maximum3_f16 v83, v83, v102, v103
    v_max_u16_sdwa v83, v83, v83 dst_sel:DWORD dst_unused:UNUSED_PAD src0_sel:WORD_1 src1_sel:WORD_0
    s_nop 1
    v_max_u32_dpp v83, v83, v83 row_shr:1 row_mask:0xf bank_mask:0xf
    s_nop 1
    v_max_u32_dpp v83, v83, v83 row_shr:2 row_mask:0xf bank_mask:0xf
    s_nop 1
    v_max_u32_dpp v83, v83, v83 row_shr:4 row_mask:0xf bank_mask:0xf
    s_nop 1
    v_max_u32_dpp v83, v83, v83 row_shr:8 row_mask:0xf bank_mask:0xf
    s_nop 1
    v_max_u32_dpp v83, v83, v83 row_bcast:15 row_mask:0xa bank_mask:0xf
    s_nop 1
    v_max_u32_dpp v83, v83, v83 row_bcast:31 row_mask:0xc bank_mask:0xf
    s_nop 0
    v_readlane_b32 s69, v83, 63
    s_nop 0
    s_lshr_b32 s69, s69, 7
    s_sub_i32 s69, s69, 30
    s_max_i32 s69, s69, 0
    s_mul_i32 s76, s69, 0x800080
    s_sub_i32 s69, s69, 112
    v_pk_sub_u16 v88, v88, s76 clamp
    v_pk_sub_u16 v89, v89, s76 clamp
    v_pk_sub_u16 v90, v90, s76 clamp
    v_pk_sub_u16 v91, v91, s76 clamp
    v_pk_sub_u16 v92, v92, s76 clamp
    v_pk_sub_u16 v93, v93, s76 clamp
    v_pk_sub_u16 v94, v94, s76 clamp
    v_pk_sub_u16 v95, v95, s76 clamp
    v_pk_sub_u16 v96, v96, s76 clamp
    v_pk_sub_u16 v97, v97, s76 clamp
    v_pk_sub_u16 v98, v98, s76 clamp
    v_pk_sub_u16 v99, v99, s76 clamp
    v_pk_sub_u16 v100, v100, s76 clamp
    v_pk_sub_u16 v101, v101, s76 clamp
    v_pk_sub_u16 v102, v102, s76 clamp
    v_pk_sub_u16 v103, v103, s76 clamp
    v_lshlrev_b32 v88, 3, v88
    v_lshlrev_b32 v89, 3, v89
    v_lshlrev_b32 v90, 3, v90
    v_lshlrev_b32 v91, 3, v91
    v_lshlrev_b32 v92, 3, v92
    v_lshlrev_b32 v93, 3, v93
    v_lshlrev_b32 v94, 3, v94
    v_lshlrev_b32 v95, 3, v95
    v_lshlrev_b32 v96, 3, v96
    v_lshlrev_b32 v97, 3, v97
    v_lshlrev_b32 v98, 3, v98
    v_lshlrev_b32 v99, 3, v99
    v_lshlrev_b32 v100, 3, v100
    v_lshlrev_b32 v101, 3, v101
    v_lshlrev_b32 v102, 3, v102
    v_lshlrev_b32 v103, 3, v103
    v_bfi_b32 v88, s78, v40, v88
    v_bfi_b32 v89, s78, v41, v89
    v_bfi_b32 v90, s78, v42, v90
    v_bfi_b32 v91, s78, v43, v91
    v_bfi_b32 v92, s78, v44, v92
    v_bfi_b32 v93, s78, v45, v93
    v_bfi_b32 v94, s78, v46, v94
    v_bfi_b32 v95, s78, v47, v95
    v_bfi_b32 v96, s78, v48, v96
    v_bfi_b32 v97, s78, v49, v97
    v_bfi_b32 v98, s78, v50, v98
    v_bfi_b32 v99, s78, v51, v99
    v_bfi_b32 v100, s78, v52, v100
    v_bfi_b32 v101, s78, v53, v101
    v_bfi_b32 v102, s78, v54, v102
    v_bfi_b32 v103, s78, v55, v103
    v_mov_b32 v81, s69
    v_mov_b32 v82, 0
    buffer_store_dwordx4 v[88:91], v79, s[64:67], s4 offen sc1
    buffer_store_dwordx4 v[96:99], v79, s[64:67], s6 offen sc1
    s_mov_b64 exec, 0x3fffff
    buffer_store_dwordx4 v[92:95], v80, s[64:67], s4 offen sc1
    buffer_store_dwordx4 v[100:103], v80, s[64:67], s6 offen sc1
    s_mov_b64 exec, 1
    buffer_store_dword v81, v82, s[64:67], s5 offen sc1
    buffer_store_dword v81, v82, s[64:67], s7 offen sc1
    s_branch L_prodfin
L_prodv5:
    s_sub_u32 s69, s81, 68
    s_cmp_ge_u32 s69, 28
    s_cselect_b32 s72, 1, 0
    s_mul_i32 s70, s72, 28
    s_sub_u32 s69, s69, s70
    s_cmp_ge_u32 s69, 26
    s_cbranch_scc1 L_noprod
    s_mul_i32 s71, s69, 52
    s_mul_i32 s70, s72, 35152
    s_add_u32 s71, s71, s70
    s_add_u32 s71, s71, 140608
    v_lshrrev_b32 v72, 2, v1
    v_and_b32 v73, 3, v1
    v_mul_u32_u24 v74, 0x548, v72
    v_lshl_add_u32 v74, v73, 4, v74
    buffer_load_dwordx4 v[40:43], v74, s[32:35], s71 offen
    s_add_u32 s71, s71, 21632
    buffer_load_dwordx4 v[44:47], v74, s[32:35], s71 offen
    v_lshlrev_b32 v75, 1, v72
    s_mul_i32 s71, s72, 52
    buffer_load_ushort v76, v75, s[36:39], s71 offen offset:208
    buffer_load_ushort v77, v75, s[36:39], s71 offen offset:240
    s_lshl_b32 s76, s69, 7
    s_add_u32 s76, s76, 167424
    s_cmp_ge_u32 s69, 13
    s_cselect_b32 s70, 1, 0
    s_mul_i32 s73, s70, 13
    s_sub_u32 s69, s69, s73
    s_lshl_b32 s73, s70, 2
    s_lshl_b32 s70, s70, 4
    s_add_u32 s70, s70, s69
    s_add_u32 s73, s73, s69
    s_and_b32 s69, s69, 12
    s_add_u32 s69, s69, s73
    s_lshl_b32 s69, s69, 4
    s_add_u32 s69, s69, 162304
    s_cmp_eq_u32 s72, 0
    s_cselect_b32 s69, s69, s76
    s_cselect_b32 s70, 10, 4
    s_movk_i32 s73, 0x200
    s_cselect_b32 s73, s73, 64
    v_lshlrev_b32 v78, s70, v73
    v_add_u32 v87, s73, v78
    s_waitcnt vmcnt(0)
    s_setprio 3
    v_mov_b32 v3, 1
    s_mov_b64 exec, 1
    ds_add_u32 v165, v3 offset:24
    s_mov_b64 exec, -1
    v_cmp_ne_u32 vcc, 3, v73
    s_waitcnt vmcnt(0)
    s_nop 0
    v_cndmask_b32 v41, 0, v41, vcc
    s_waitcnt vmcnt(0)
    v_cndmask_b32 v45, 0, v45, vcc
    v_cndmask_b32 v42, 0, v42, vcc
    v_cndmask_b32 v46, 0, v46, vcc
    v_cndmask_b32 v43, 0, v43, vcc
    v_cndmask_b32 v47, 0, v47, vcc
    s_waitcnt vmcnt(0)
    v_lshlrev_b32 v76, 16, v76
    s_waitcnt vmcnt(0)
    v_lshlrev_b32 v77, 16, v77
    v_cmp_gt_u32 vcc, 10, v72
    s_nop 1
    v_cndmask_b32 v77, 0, v77, vcc
    v_lshlrev_b32 v79, 16, v40
    v_and_b32 v80, 0xffff0000, v40
    v_lshlrev_b32 v81, 16, v44
    v_and_b32 v82, 0xffff0000, v44
    v_mul_f32 v48, v76, v79
    v_mul_f32 v49, v76, v80
    v_fmac_f32 v48, v77, v81
    v_fmac_f32 v49, v77, v82
    v_lshlrev_b32 v79, 16, v41
    v_and_b32 v80, 0xffff0000, v41
    v_lshlrev_b32 v81, 16, v45
    v_and_b32 v82, 0xffff0000, v45
    v_mul_f32 v50, v76, v79
    v_mul_f32 v51, v76, v80
    v_fmac_f32 v50, v77, v81
    v_fmac_f32 v51, v77, v82
    v_lshlrev_b32 v79, 16, v42
    v_and_b32 v80, 0xffff0000, v42
    v_lshlrev_b32 v81, 16, v46
    v_and_b32 v82, 0xffff0000, v46
    v_mul_f32 v52, v76, v79
    v_mul_f32 v53, v76, v80
    v_fmac_f32 v52, v77, v81
    v_fmac_f32 v53, v77, v82
    v_lshlrev_b32 v79, 16, v43
    v_and_b32 v80, 0xffff0000, v43
    v_lshlrev_b32 v81, 16, v47
    v_and_b32 v82, 0xffff0000, v47
    v_mul_f32 v54, v76, v79
    v_mul_f32 v55, v76, v80
    v_fmac_f32 v54, v77, v81
    v_fmac_f32 v55, v77, v82
    v_add_f32_dpp v48, v48, v48 row_ror:4 row_mask:0xf bank_mask:0xf
    v_add_f32_dpp v49, v49, v49 row_ror:4 row_mask:0xf bank_mask:0xf
    v_add_f32_dpp v50, v50, v50 row_ror:4 row_mask:0xf bank_mask:0xf
    v_add_f32_dpp v51, v51, v51 row_ror:4 row_mask:0xf bank_mask:0xf
    v_add_f32_dpp v52, v52, v52 row_ror:4 row_mask:0xf bank_mask:0xf
    v_add_f32_dpp v53, v53, v53 row_ror:4 row_mask:0xf bank_mask:0xf
    v_add_f32_dpp v54, v54, v54 row_ror:4 row_mask:0xf bank_mask:0xf
    v_add_f32_dpp v55, v55, v55 row_ror:4 row_mask:0xf bank_mask:0xf
    v_add_f32_dpp v48, v48, v48 row_ror:8 row_mask:0xf bank_mask:0xf
    v_add_f32_dpp v49, v49, v49 row_ror:8 row_mask:0xf bank_mask:0xf
    v_add_f32_dpp v50, v50, v50 row_ror:8 row_mask:0xf bank_mask:0xf
    v_add_f32_dpp v51, v51, v51 row_ror:8 row_mask:0xf bank_mask:0xf
    v_add_f32_dpp v52, v52, v52 row_ror:8 row_mask:0xf bank_mask:0xf
    v_add_f32_dpp v53, v53, v53 row_ror:8 row_mask:0xf bank_mask:0xf
    v_add_f32_dpp v54, v54, v54 row_ror:8 row_mask:0xf bank_mask:0xf
    v_add_f32_dpp v55, v55, v55 row_ror:8 row_mask:0xf bank_mask:0xf
    v_mov_b32 v79, v48
    v_mov_b32 v80, v49
    v_mov_b32 v81, v50
    v_mov_b32 v82, v51
    v_mov_b32 v83, v52
    v_mov_b32 v84, v53
    v_mov_b32 v85, v54
    v_mov_b32 v86, v55
    v_permlane16_swap_b32 v48, v79
    v_permlane16_swap_b32 v49, v80
    v_permlane16_swap_b32 v50, v81
    v_permlane16_swap_b32 v51, v82
    v_permlane16_swap_b32 v52, v83
    v_permlane16_swap_b32 v53, v84
    v_permlane16_swap_b32 v54, v85
    v_permlane16_swap_b32 v55, v86
    v_add_f32 v48, v48, v79
    v_add_f32 v49, v49, v80
    v_add_f32 v50, v50, v81
    v_add_f32 v51, v51, v82
    v_add_f32 v52, v52, v83
    v_add_f32 v53, v53, v84
    v_add_f32 v54, v54, v85
    v_add_f32 v55, v55, v86
    v_mov_b32 v79, v48
    v_mov_b32 v80, v49
    v_mov_b32 v81, v50
    v_mov_b32 v82, v51
    v_mov_b32 v83, v52
    v_mov_b32 v84, v53
    v_mov_b32 v85, v54
    v_mov_b32 v86, v55
    v_permlane32_swap_b32 v48, v79
    v_permlane32_swap_b32 v49, v80
    v_permlane32_swap_b32 v50, v81
    v_permlane32_swap_b32 v51, v82
    v_permlane32_swap_b32 v52, v83
    v_permlane32_swap_b32 v53, v84
    v_permlane32_swap_b32 v54, v85
    v_permlane32_swap_b32 v55, v86
    v_add_f32 v48, v48, v79
    v_add_f32 v49, v49, v80
    v_add_f32 v50, v50, v81
    v_add_f32 v51, v51, v82
    v_add_f32 v52, v52, v83
    v_add_f32 v53, v53, v84
    v_add_f32 v54, v54, v85
    v_add_f32 v55, v55, v86
    v_cvt_pk_bf16_f32 v40, v48, v49
    v_lshlrev_b32 v79, 16, v40
    v_and_b32 v80, 0xffff0000, v40
    v_sub_f32 v79, v48, v79
    v_sub_f32 v80, v49, v80
    v_cvt_pk_bf16_f32 v44, v79, v80
    v_cvt_pk_bf16_f32 v41, v50, v51
    v_lshlrev_b32 v79, 16, v41
    v_and_b32 v80, 0xffff0000, v41
    v_sub_f32 v79, v50, v79
    v_sub_f32 v80, v51, v80
    v_cvt_pk_bf16_f32 v45, v79, v80
    v_cvt_pk_bf16_f32 v42, v52, v53
    v_lshlrev_b32 v79, 16, v42
    v_and_b32 v80, 0xffff0000, v42
    v_sub_f32 v79, v52, v79
    v_sub_f32 v80, v53, v80
    v_cvt_pk_bf16_f32 v46, v79, v80
    v_cvt_pk_bf16_f32 v43, v54, v55
    v_lshlrev_b32 v79, 16, v43
    v_and_b32 v80, 0xffff0000, v43
    v_sub_f32 v79, v54, v79
    v_sub_f32 v80, v55, v80
    v_cvt_pk_bf16_f32 v47, v79, v80
    s_mov_b64 exec, 0xf
    buffer_store_dwordx4 v[40:43], v78, s[64:67], s69 offen sc1
    buffer_store_dwordx4 v[44:47], v87, s[64:67], s69 offen sc1
L_prodfin:
    s_mov_b64 exec, -1
    s_branch L_afterprod
L_noprod:
    s_waitcnt vmcnt(0)
    v_mov_b32 v3, 1
    s_mov_b64 exec, 1
    ds_add_u32 v165, v3 offset:24
    s_mov_b64 exec, -1
L_afterprod:
    s_waitcnt lgkmcnt(0)
    s_nop 11
    v_and_b32 v2, 31, v1
    v_lshlrev_b32 v2, 2, v2
    s_mul_i32 s69, s68, 1664
    s_add_u32 s69, s69, 143104
    v_add_u32 v39, s69, v2
    v_lshrrev_b32 v6, 4, v1
    v_lshrrev_b32 v2, 2, v1
    v_mul_u32_u24 v2, 224, v2
    v_and_b32 v7, 3, v1
    v_lshl_add_u32 v2, v7, 3, v2
    v_mov_b32 v162, v2
    v_add_u32 v163, 121600, v162
    s_lshl_b32 s70, s89, 5
    s_add_u32 s70, s70, 162048
    v_lshlrev_b32 v6, 3, v6
    v_add_u32 v164, s70, v6
    v_mov_b32 v165, 163712
    s_lshl_b32 s69, s68, 2
    s_add_u32 s69, s69, 163744
    v_mov_b32 v167, s69
    s_cmp_gt_u32 s68, 2
    s_cbranch_scc1 L_nopw2
    v_lshlrev_b32 v136, 16, v136
    v_lshlrev_b32 v2, 2, v0
    v_add_u32 v2, 161408, v2
    v_cmp_gt_u32 vcc, 0xa0, v0
    s_nop 0
    s_mov_b64 exec, vcc
    ds_write_b32 v2, v136
    s_mov_b64 exec, -1
L_nopw2:
    s_waitcnt lgkmcnt(0)
    s_cmp_ge_u32 s86, 31
    s_cbranch_scc1 L_nocnt
    s_waitcnt vmcnt(0)
    v_mov_b32 v158, 1
    s_mov_b64 exec, 1
    ds_add_rtn_u32 v159, v165, v158 offset:12
    s_memrealtime s[84:85]
    s_waitcnt lgkmcnt(0)
    v_readfirstlane_b32 s69, v159
    s_nop 0
    s_cmp_lg_u32 s69, 3
    s_cbranch_scc1 L_nocnt
    s_mov_b32 s69, 136
    s_mov_b32 s70, 6
    s_mov_b32 s71, 0
    s_cmp_ge_u32 s86, 7
    s_cselect_b32 s69, 128, s69
    s_cselect_b32 s70, 16, s70
    s_cselect_b32 s71, 4, s71
    s_cmp_ge_u32 s86, 24
    s_cselect_b32 s69, 64, s69
    s_cselect_b32 s70, 6, s70
    s_cselect_b32 s71, 8, s71
    v_mov_b32 v159, s71
    buffer_atomic_add v158, v159, s[60:63], 0 offen sc0 sc1
    s_waitcnt vmcnt(0)
    v_readfirstlane_b32 s71, v158
    s_nop 0
    s_cmp_lg_u32 s71, s70
    s_cbranch_scc1 L_nocnt
    s_or_b32 s84, s84, 1
    v_mov_b32 v158, s84
    v_mov_b32 v160, s69
    buffer_store_dword v158, v160, s[60:63], 0 offen sc1
L_nocnt:
    s_mov_b64 exec, -1
    s_setprio 0
    s_mov_b32 s91, 0
    v_bfe_u32 v2, v1, 4, 1
    v_mul_u32_u24 v2, 104, v2
    v_and_b32 v3, 12, v1
    v_add_u32 v2, v2, v3
    s_mul_i32 s69, s68, 208
    s_add_u32 s69, s69, 103680
    v_add_u32 v10, s69, v2
    v_and_b32 v8, 3, v1
    v_lshlrev_b32 v8, 3, v8
    v_add_u32 v8, 71680, v8
    v_lshrrev_b32 v9, 4, v1
    v_lshlrev_b32 v9, 3, v9
    v_add_u32 v9, 71680, v9
    v_and_b32 v11, 15, v1
    v_mul_u32_u24 v11, 104, v11
    ds_read_b32 v166, v165 offset:24
    s_waitcnt lgkmcnt(0)
    v_readfirstlane_b32 s69, v166
    s_nop 0
    s_cmp_ge_u32 s69, 8
    s_cbranch_scc1 L_ok0
    s_mov_b32 s70, 0x100000
L_sp0:
    s_sleep 1
    ds_read_b32 v166, v165 offset:24
    s_sub_u32 s70, s70, 1
    s_cbranch_scc1 L_ok0
    s_waitcnt lgkmcnt(0)
    v_readfirstlane_b32 s69, v166
    s_nop 0
    s_cmp_ge_u32 s69, 8
    s_cbranch_scc0 L_sp0
L_ok0:
    ds_read_b32 v96, v10 offset:0
    ds_read_b32 v97, v10 offset:16
    ds_read_b32 v98, v10 offset:32
    ds_read_b32 v99, v10 offset:48
    ds_read_b32 v100, v10 offset:64
    ds_read_b32 v101, v10 offset:80
    ds_read_b32 v102, v10 offset:96
    s_cmp_lt_u32 s68, 4
    s_cbranch_scc1 L_noix
    s_setprio 3
    s_and_b32 s69, s68, 3
    s_mul_i32 s69, s69, 1664
    s_add_u32 s69, s69, 103680
    s_add_u32 s71, s69, 104
    s_lshl_b32 s90, s83, 3
    s_add_u32 s90, s90, s69
    v_add_u32 v4, s90, v11
    ds_read_b64 v[132:133], v4
    s_add_u32 s90, s90, 8
    s_cmp_eq_u32 s90, s71
    s_cselect_b32 s90, s69, s90
    v_add_u32 v5, s90, v11
    ds_read_b64 v[134:135], v5
    s_add_u32 s90, s90, 8
    s_cmp_eq_u32 s90, s71
    s_cselect_b32 s90, s69, s90
    v_add_u32 v6, s90, v11
    ds_read_b64 v[136:137], v6
    s_add_u32 s90, s90, 8
    s_cmp_eq_u32 s90, s71
    s_cselect_b32 s90, s69, s90
    v_add_u32 v7, s90, v11
    ds_read_b64 v[138:139], v7
    s_add_u32 s90, s90, 8
    s_cmp_eq_u32 s90, s71
    s_cselect_b32 s90, s69, s90
    v_add_u32 v4, s90, v11
    ds_read_b64 v[140:141], v4
    s_add_u32 s90, s90, 8
    s_cmp_eq_u32 s90, s71
    s_cselect_b32 s90, s69, s90
    v_add_u32 v5, s90, v11
    ds_read_b64 v[142:143], v5
    s_add_u32 s90, s90, 8
    s_cmp_eq_u32 s90, s71
    s_cselect_b32 s90, s69, s90
    v_add_u32 v6, s90, v11
    ds_read_b64 v[144:145], v6
    s_add_u32 s90, s90, 8
    s_cmp_eq_u32 s90, s71
    s_cselect_b32 s90, s69, s90
    v_add_u32 v7, s90, v11
    ds_read_b64 v[146:147], v7
    s_add_u32 s90, s90, 8
    s_cmp_eq_u32 s90, s71
    s_cselect_b32 s90, s69, s90
    v_add_u32 v4, s90, v11
    ds_read_b64 v[148:149], v4
    s_add_u32 s90, s90, 8
    s_cmp_eq_u32 s90, s71
    s_cselect_b32 s90, s69, s90
    v_add_u32 v5, s90, v11
    ds_read_b64 v[150:151], v5
    s_add_u32 s90, s90, 8
    s_cmp_eq_u32 s90, s71
    s_cselect_b32 s90, s69, s90
    v_add_u32 v6, s90, v11
    ds_read_b64 v[152:153], v6
    s_add_u32 s90, s90, 8
    s_cmp_eq_u32 s90, s71
    s_cselect_b32 s90, s69, s90
    v_add_u32 v7, s90, v11
    ds_read_b64 v[154:155], v7
    s_add_u32 s90, s90, 8
    s_cmp_eq_u32 s90, s71
    s_cselect_b32 s90, s69, s90
    v_add_u32 v4, s90, v11
    ds_read_b64 v[156:157], v4
    ds_read_b64 v[104:105], v164 offset:0
    ds_read_b64 v[106:107], v164 offset:32
    ds_read_b64 v[108:109], v164 offset:64
    ds_read_b64 v[110:111], v164 offset:96
    ds_read_b64 v[112:113], v164 offset:128
    ds_read_b64 v[114:115], v164 offset:160
    ds_read_b64 v[116:117], v164 offset:192
L_noix:
    s_waitcnt lgkmcnt(6)
    v_min_u32 v96, 0x3e7, v96
    v_lshl_add_u32 v96, v96, 5, v8
    ds_read_b64_tr_b16 v[68:69], v96
    s_waitcnt lgkmcnt(6)
    v_min_u32 v97, 0x3e7, v97
    v_lshl_add_u32 v97, v97, 5, v8
    ds_read_b64_tr_b16 v[70:71], v97
    s_waitcnt lgkmcnt(6)
    v_min_u32 v98, 0x3e7, v98
    v_lshl_add_u32 v98, v98, 5, v8
    ds_read_b64_tr_b16 v[72:73], v98
    s_waitcnt lgkmcnt(6)
    v_min_u32 v99, 0x3e7, v99
    v_lshl_add_u32 v99, v99, 5, v8
    ds_read_b64_tr_b16 v[74:75], v99
    s_waitcnt lgkmcnt(6)
    v_min_u32 v100, 0x3e7, v100
    v_lshl_add_u32 v100, v100, 5, v8
    ds_read_b64_tr_b16 v[76:77], v100
    s_waitcnt lgkmcnt(6)
    v_min_u32 v101, 0x3e7, v101
    v_lshl_add_u32 v101, v101, 5, v8
    ds_read_b64_tr_b16 v[78:79], v101
    s_waitcnt lgkmcnt(6)
    v_min_u32 v102, 0x3e7, v102
    v_lshl_add_u32 v102, v102, 5, v8
    ds_read_b64_tr_b16 v[80:81], v102
    s_waitcnt lgkmcnt(6)
    ds_write_b32 v39, v68 offset:0
    ds_write_b32 v39, v69 offset:128
    s_waitcnt lgkmcnt(7)
    ds_write_b32 v39, v70 offset:256
    ds_write_b32 v39, v71 offset:384
    s_waitcnt lgkmcnt(8)
    ds_write_b32 v39, v72 offset:512
    ds_write_b32 v39, v73 offset:640
    s_waitcnt lgkmcnt(9)
    ds_write_b32 v39, v74 offset:768
    ds_write_b32 v39, v75 offset:896
    s_waitcnt lgkmcnt(10)
    ds_write_b32 v39, v76 offset:1024
    ds_write_b32 v39, v77 offset:1152
    s_waitcnt lgkmcnt(11)
    ds_write_b32 v39, v78 offset:1280
    ds_write_b32 v39, v79 offset:1408
    s_waitcnt lgkmcnt(12)
    ds_write_b32 v39, v80 offset:1536
    s_waitcnt lgkmcnt(0)
    s_cmp_ge_u32 s68, 4
    s_cbranch_scc1 L_grpB
    v_mov_b32 v2, 3
    ds_write_b32 v167, v2
    s_cmp_lt_u32 s86, 32
    s_cbranch_scc1 L_x0prep
    s_cmp_ge_u32 s86, 39
    s_cbranch_scc1 L_x0prep
    s_sub_u32 s94, s86, 32
    s_lshl_b32 s94, s94, 2
    s_and_b32 s73, s68, 3
    s_add_u32 s94, s94, s73
    s_mul_i32 s72, s73, 1664
    s_add_u32 s72, s72, 113664
    v_lshrrev_b32 v84, 2, v1
    v_and_b32 v85, 3, v1
    v_mul_u32_u24 v86, 0x548, v84
    v_lshl_add_u32 v86, v85, 4, v86
    s_min_u32 s71, s94, 25
    s_mul_i32 s71, s71, 52
    s_add_u32 s71, s71, 140608
    s_mov_b32 m0, s72
    s_nop 0
    buffer_load_dwordx4 v86, s[32:35], s71 offen lds
    s_add_u32 m0, s72, 1024
    s_add_u32 s71, s71, 21632
    s_mov_b32 exec_hi, 0xff
    buffer_load_dwordx4 v86, s[32:35], s71 offen lds
    s_mov_b64 exec, -1
    v_mov_b32 v142, 0
    s_mov_b32 s69, 0
L_tpoll:
    s_mov_b64 exec, 1
    buffer_load_dword v140, v142, s[60:63], 0 offen offset:64 sc1
    s_mov_b64 exec, -1
    s_add_u32 s69, s69, 1
    s_waitcnt vmcnt(0)
    v_readfirstlane_b32 s70, v140
    s_nop 0
    s_cmp_lg_u32 s70, 0
    s_cbranch_scc1 L_tgo
    s_sleep 6
    s_cmp_lt_u32 s69, 0x40000
    s_cbranch_scc1 L_tpoll
L_tgo:
    s_mul_i32 s71, s73, 832
    s_add_u32 m0, s71, 110336
    s_add_u32 s71, s71, 167424
    s_mov_b32 exec_hi, 0xfffff
    buffer_load_dwordx4 v31, s[64:67], s71 offen sc1 lds
    s_mov_b64 exec, -1
    v_lshrrev_b32 v87, 5, v1
    v_bfe_u32 v88, v1, 2, 2
    v_lshl_add_u32 v87, v87, 3, v88
    v_bfe_u32 v88, v1, 4, 1
    v_lshlrev_b32 v88, 5, v88
    v_lshl_add_u32 v88, v85, 3, v88
    v_lshl_add_u32 v143, v87, 6, v88
    v_add_u32 v143, s72, v143
    v_lshl_add_u32 v146, v87, 7, v88
    v_add_u32 v146, 110336, v146
    v_mov_b32 v89, 0x30000
    v_cmp_gt_u32 vcc, 10, v87
    s_nop 1
    v_cndmask_b32 v144, v89, v143, vcc
    v_cndmask_b32 v147, v89, v146, vcc
    v_cmp_gt_u32 vcc, 6, v87
    s_nop 1
    v_cndmask_b32 v145, v89, v143, vcc
    v_cndmask_b32 v148, v89, v146, vcc
    v_and_b32 v84, 31, v1
    v_lshrrev_b32 v85, 5, v1
    s_min_u32 s76, s94, 25
    v_lshrrev_b32 v87, 1, v84
    v_and_b32 v88, 1, v84
    v_subrev_u32 v89, 1, v87
    v_mul_i32_i24 v89, v89, v87
    v_lshrrev_b32 v89, 1, v89
    v_mul_u32_u24 v90, 12, v87
    v_sub_u32 v90, v90, v89
    v_mul_u32_u24 v89, 92, v88
    v_add_u32 v90, v90, v89
    v_lshl_add_u32 v90, v85, 1, v90
    v_lshlrev_b32 v90, 2, v90
    v_add_u32 v90, s72, v90
    v_lshlrev_b32 v89, 1, v85
    v_sub_u32 v87, v87, v89
    v_cmp_gt_u32 vcc, 26, v84
    v_mov_b32 v89, 100
    s_nop 0
    v_cndmask_b32 v87, v89, v87, vcc
    v_add_u32 v92, s72, v31
    v_cmp_le_u32 vcc, 23, v1
    s_nop 1
    v_cndmask_b32 v93, 0, 1, vcc
    s_mov_b32 s69, s76
    s_cmp_ge_u32 s69, 13
    s_cselect_b32 s70, 1, 0
    s_mul_i32 s73, s70, 13
    s_sub_u32 s69, s69, s73
    s_lshl_b32 s73, s70, 2
    s_lshl_b32 s70, s70, 4
    s_add_u32 s70, s70, s69
    s_add_u32 s73, s73, s69
    s_and_b32 s69, s69, 12
    s_add_u32 s69, s69, s73
    s_add_u32 s69, s69, 1
    s_cmp_eq_u32 s69, 29
    s_cselect_b32 s69, 0, s69
    v_mul_u32_u24 v93, 9200, v93
    v_add_u32 v93, v93, v31
    s_mul_i32 s69, s69, 368
    s_add_u32 s69, s69, 126528
    s_mov_b32 s95, s69
    s_mov_b32 s96, s70
    s_waitcnt vmcnt(0)
    v_mov_b32 v140, 1
    s_mov_b64 exec, 0x1
    ds_add_u32 v165, v140 offset:16
    s_mov_b64 exec, -1
    ds_read_b64_tr_b16 v[116:117], v143 offset:0
    ds_read_b64_tr_b16 v[118:119], v143 offset:256
    ds_read_b64_tr_b16 v[120:121], v144 offset:1024
    ds_read_b64_tr_b16 v[122:123], v145 offset:1280
    ds_read_b32 v166, v165 offset:16
    s_waitcnt lgkmcnt(0)
    v_readfirstlane_b32 s69, v166
    s_nop 0
    s_cmp_ge_u32 s69, 4
    s_cbranch_scc1 L_ok1
    s_mov_b32 s70, 0x100000
L_sp1:
    s_sleep 1
    ds_read_b32 v166, v165 offset:16
    s_sub_u32 s70, s70, 1
    s_cbranch_scc1 L_ok1
    s_waitcnt lgkmcnt(0)
    v_readfirstlane_b32 s69, v166
    s_nop 0
    s_cmp_ge_u32 s69, 4
    s_cbranch_scc0 L_sp1
L_ok1:
    ds_read_b64_tr_b16 v[124:125], v146 offset:0
    ds_read_b64_tr_b16 v[126:127], v146 offset:512
    ds_read_b64_tr_b16 v[128:129], v147 offset:2048
    ds_read_b64_tr_b16 v[130:131], v148 offset:2560
    ds_read_b64_tr_b16 v[132:133], v146 offset:64
    ds_read_b64_tr_b16 v[134:135], v146 offset:576
    ds_read_b64_tr_b16 v[136:137], v147 offset:2112
    ds_read_b64_tr_b16 v[138:139], v148 offset:2624
    s_waitcnt lgkmcnt(6)
    v_mfma_f32_32x32x16_bf16 v[100:115], v[116:119], v[124:127], 0
    v_mfma_f32_32x32x16_bf16 v[100:115], v[124:127], v[116:119], v[100:115]
    s_waitcnt lgkmcnt(4)
    v_mfma_f32_32x32x16_bf16 v[100:115], v[120:123], v[128:131], v[100:115]
    v_mfma_f32_32x32x16_bf16 v[100:115], v[128:131], v[120:123], v[100:115]
    s_waitcnt lgkmcnt(2)
    v_mfma_f32_32x32x16_bf16 v[100:115], v[116:119], v[132:135], v[100:115]
    v_mfma_f32_32x32x16_bf16 v[100:115], v[132:135], v[116:119], v[100:115]
    s_waitcnt lgkmcnt(0)
    v_mfma_f32_32x32x16_bf16 v[100:115], v[120:123], v[136:139], v[100:115]
    v_mfma_f32_32x32x16_bf16 v[100:115], v[136:139], v[120:123], v[100:115]
    s_mov_b32 s69, s95
    s_mov_b32 s70, s96
    s_nop 9
    v_max3_f32 v94, |v100|, |v101|, |v102|
    v_max3_f32 v94, |v103|, |v104|, v94
    v_max3_f32 v94, |v105|, |v106|, v94
    v_max3_f32 v94, |v107|, |v108|, v94
    v_max3_f32 v94, |v109|, |v110|, v94
    v_max3_f32 v94, |v111|, |v112|, v94
    v_max3_f32 v94, |v113|, |v114|, v94
    s_nop 1
    v_max_u32_dpp v94, v94, v94 row_shr:1 row_mask:0xf bank_mask:0xf
    s_nop 1
    v_max_u32_dpp v94, v94, v94 row_shr:2 row_mask:0xf bank_mask:0xf
    s_nop 1
    v_max_u32_dpp v94, v94, v94 row_shr:4 row_mask:0xf bank_mask:0xf
    s_nop 1
    v_max_u32_dpp v94, v94, v94 row_shr:8 row_mask:0xf bank_mask:0xf
    s_nop 1
    v_max_u32_dpp v94, v94, v94 row_bcast:15 row_mask:0xa bank_mask:0xf
    s_nop 1
    v_max_u32_dpp v94, v94, v94 row_bcast:31 row_mask:0xc bank_mask:0xf
    v_frexp_exp_i32_f32 v94, v94
    s_nop 0
    v_readlane_b32 s73, v94, 63
    s_nop 0
    s_sub_i32 s76, 15, s73
    s_sub_i32 s73, s73, 15
    v_ldexp_f32 v100, v100, s76
    v_ldexp_f32 v101, v101, s76
    v_ldexp_f32 v102, v102, s76
    v_ldexp_f32 v103, v103, s76
    v_ldexp_f32 v104, v104, s76
    v_ldexp_f32 v105, v105, s76
    v_ldexp_f32 v106, v106, s76
    v_ldexp_f32 v107, v107, s76
    v_ldexp_f32 v108, v108, s76
    v_ldexp_f32 v109, v109, s76
    v_ldexp_f32 v110, v110, s76
    v_ldexp_f32 v111, v111, s76
    v_ldexp_f32 v112, v112, s76
    v_ldexp_f32 v113, v113, s76
    v_cvt_pk_f16_f32 v116, v100, v101
    v_cvt_pk_f16_f32 v117, v102, v103
    v_cvt_pk_f16_f32 v118, v104, v105
    v_cvt_pk_f16_f32 v119, v106, v107
    v_cvt_pk_f16_f32 v120, v108, v109
    v_cvt_pk_f16_f32 v121, v110, v111
    v_cvt_pk_f16_f32 v122, v112, v113
    v_mov_b32 v91, 0
    v_mov_b32 v97, s72
    ds_write_b32 v97, v91 offset:364
    ds_write_b32 v97, v91 offset:732
    v_cmp_ge_i32 vcc, 0, v87
    s_nop 0
    s_mov_b64 exec, vcc
    ds_write_b32 v90, v116 offset:0
    s_mov_b64 exec, -1
    v_cmp_ge_i32 vcc, 1, v87
    s_nop 0
    s_mov_b64 exec, vcc
    ds_write_b32 v90, v117 offset:4
    s_mov_b64 exec, -1
    v_cmp_ge_i32 vcc, 4, v87
    s_nop 0
    s_mov_b64 exec, vcc
    ds_write_b32 v90, v118 offset:16
    s_mov_b64 exec, -1
    v_cmp_ge_i32 vcc, 5, v87
    s_nop 0
    s_mov_b64 exec, vcc
    ds_write_b32 v90, v119 offset:20
    s_mov_b64 exec, -1
    v_cmp_ge_i32 vcc, 8, v87
    s_nop 0
    s_mov_b64 exec, vcc
    ds_write_b32 v90, v120 offset:32
    s_mov_b64 exec, -1
    v_cmp_ge_i32 vcc, 9, v87
    s_nop 0
    s_mov_b64 exec, vcc
    ds_write_b32 v90, v121 offset:36
    s_mov_b64 exec, -1
    v_cmp_ge_i32 vcc, 12, v87
    s_nop 0
    s_mov_b32 vcc_hi, 0
    s_mov_b64 exec, vcc
    ds_write_b32 v90, v122 offset:48
    s_mov_b64 exec, -1
    s_waitcnt lgkmcnt(0)
    ds_read_b128 v[124:127], v92
    s_mov_b32 exec_hi, 0x3fff
    s_waitcnt lgkmcnt(0)
    buffer_store_dwordx4 v[124:127], v93, s[64:67], s69 offen sc1
    s_mov_b64 exec, -1
    s_lshl_b32 s70, s70, 2
    s_add_u32 s70, s70, 166912
    v_mov_b32 v95, s73
    v_mov_b32 v96, s70
    s_mov_b64 exec, 1
    buffer_store_dword v95, v96, s[64:67], 0 offen sc1
    s_waitcnt vmcnt(0)
    v_mov_b32 v158, 1
    ds_add_rtn_u32 v159, v165, v158 offset:20
    s_waitcnt lgkmcnt(0)
    v_readfirstlane_b32 s69, v159
    s_nop 0
    s_cmp_lg_u32 s69, 3
    s_cbranch_scc1 L_tdone
    v_mov_b32 v159, s92
    buffer_atomic_add v158, v159, s[60:63], 0 offen offset:12 sc0 sc1
    s_waitcnt vmcnt(0)
    v_readfirstlane_b32 s71, v158
    v_mov_b32 v159, 0
    v_mov_b32 v158, 1
    s_cmp_lg_u32 s71, 6
    s_cbranch_scc1 L_tdone
    buffer_store_dword v158, v159, s[60:63], 0 offen offset:192 sc1
L_tdone:
    s_mov_b64 exec, -1
    s_nop 3
    s_branch L_x0prep
L_grpB:
    v_lshl_add_u32 v132, v132, 5, v9
    v_lshl_add_u32 v133, v133, 5, v9
    v_lshl_add_u32 v134, v134, 5, v9
    v_lshl_add_u32 v135, v135, 5, v9
    v_lshl_add_u32 v136, v136, 5, v9
    v_lshl_add_u32 v137, v137, 5, v9
    v_lshl_add_u32 v138, v138, 5, v9
    v_lshl_add_u32 v139, v139, 5, v9
    v_lshl_add_u32 v140, v140, 5, v9
    v_lshl_add_u32 v141, v141, 5, v9
    v_lshl_add_u32 v142, v142, 5, v9
    v_lshl_add_u32 v143, v143, 5, v9
    v_lshl_add_u32 v144, v144, 5, v9
    v_lshl_add_u32 v145, v145, 5, v9
    v_lshl_add_u32 v146, v146, 5, v9
    v_lshl_add_u32 v147, v147, 5, v9
    v_lshl_add_u32 v148, v148, 5, v9
    v_lshl_add_u32 v149, v149, 5, v9
    v_lshl_add_u32 v150, v150, 5, v9
    v_lshl_add_u32 v151, v151, 5, v9
    v_lshl_add_u32 v152, v152, 5, v9
    v_lshl_add_u32 v153, v153, 5, v9
    v_lshl_add_u32 v154, v154, 5, v9
    v_lshl_add_u32 v155, v155, 5, v9
    v_lshl_add_u32 v156, v156, 5, v9
    v_lshl_add_u32 v157, v157, 5, v9
    v_lshlrev_b32 v40, 16, v104
    v_and_b32 v41, 0xffff0000, v104
    v_lshlrev_b32 v42, 16, v105
    v_and_b32 v43, 0xffff0000, v105
    v_lshlrev_b32 v44, 16, v106
    v_and_b32 v45, 0xffff0000, v106
    v_lshlrev_b32 v46, 16, v107
    v_and_b32 v47, 0xffff0000, v107
    v_lshlrev_b32 v48, 16, v108
    v_and_b32 v49, 0xffff0000, v108
    v_lshlrev_b32 v50, 16, v109
    v_and_b32 v51, 0xffff0000, v109
    v_lshlrev_b32 v52, 16, v110
    v_and_b32 v53, 0xffff0000, v110
    v_lshlrev_b32 v54, 16, v111
    v_and_b32 v55, 0xffff0000, v111
    v_lshlrev_b32 v56, 16, v112
    v_and_b32 v57, 0xffff0000, v112
    v_lshlrev_b32 v58, 16, v113
    v_and_b32 v59, 0xffff0000, v113
    v_lshlrev_b32 v60, 16, v114
    v_and_b32 v61, 0xffff0000, v114
    v_lshlrev_b32 v62, 16, v115
    v_and_b32 v63, 0xffff0000, v115
    v_lshlrev_b32 v64, 16, v116
    v_and_b32 v65, 0xffff0000, v116
    v_lshlrev_b32 v66, 16, v117
    v_and_b32 v67, 0xffff0000, v117
    s_cmp_ge_u32 s79, 2
    s_cbranch_scc1 L_dnn0
    s_cmp_ge_u32 s91, 3
    s_cbranch_scc1 L_ok2
    s_mov_b32 s70, 0x100000
L_sp2:
    ds_read_b32 v166, v165
    s_sub_u32 s70, s70, 1
    s_cbranch_scc1 L_ok2
    s_waitcnt lgkmcnt(0)
    v_readfirstlane_b32 s91, v166
    s_nop 0
    s_cmp_ge_u32 s91, 3
    s_cbranch_scc1 L_ok2
    s_sleep 1
    s_branch L_sp2
L_ok2:
    ds_read_b64 v[124:125], v132
    ds_read_b64 v[126:127], v133
    ds_read_b64_tr_b16 v[68:69], v163 offset:0
    ds_read_b64_tr_b16 v[70:71], v163 offset:3584
    ds_read_b64_tr_b16 v[72:73], v163 offset:32
    ds_read_b64_tr_b16 v[74:75], v163 offset:3616
    ds_read_b64_tr_b16 v[76:77], v163 offset:64
    ds_read_b64_tr_b16 v[78:79], v163 offset:3648
    ds_read_b64_tr_b16 v[80:81], v163 offset:96
    ds_read_b64_tr_b16 v[82:83], v163 offset:3680
    ds_read_b64_tr_b16 v[84:85], v163 offset:128
    ds_read_b64_tr_b16 v[86:87], v163 offset:3712
    ds_read_b64_tr_b16 v[88:89], v163 offset:160
    ds_read_b64_tr_b16 v[90:91], v163 offset:3744
    ds_read_b64_tr_b16 v[92:93], v163 offset:192
    ds_read_b64_tr_b16 v[94:95], v163 offset:3776
    ds_read_b64 v[128:129], v134
    ds_read_b64 v[130:131], v135
    s_waitcnt lgkmcnt(14)
    v_mfma_f32_16x16x32_bf16 v[40:43], v[68:71], v[124:127], v[40:43]
    ds_read_b64_tr_b16 v[96:97], v163 offset:7168
    ds_read_b64_tr_b16 v[98:99], v163 offset:10752
    s_waitcnt lgkmcnt(14)
    v_mfma_f32_16x16x32_bf16 v[44:47], v[72:75], v[124:127], v[44:47]
    ds_read_b64_tr_b16 v[100:101], v163 offset:7200
    ds_read_b64_tr_b16 v[102:103], v163 offset:10784
    s_waitcnt lgkmcnt(14)
    v_mfma_f32_16x16x32_bf16 v[48:51], v[76:79], v[124:127], v[48:51]
    ds_read_b64_tr_b16 v[104:105], v163 offset:7232
    ds_read_b64_tr_b16 v[106:107], v163 offset:10816
    s_waitcnt lgkmcnt(14)
    v_mfma_f32_16x16x32_bf16 v[52:55], v[80:83], v[124:127], v[52:55]
    ds_read_b64_tr_b16 v[108:109], v163 offset:7264
    ds_read_b64_tr_b16 v[110:111], v163 offset:10848
    s_waitcnt lgkmcnt(14)
    v_mfma_f32_16x16x32_bf16 v[56:59], v[84:87], v[124:127], v[56:59]
    ds_read_b64_tr_b16 v[112:113], v163 offset:7296
    ds_read_b64_tr_b16 v[114:115], v163 offset:10880
    s_waitcnt lgkmcnt(14)
    v_mfma_f32_16x16x32_bf16 v[60:63], v[88:91], v[124:127], v[60:63]
    ds_read_b64_tr_b16 v[116:117], v163 offset:7328
    ds_read_b64_tr_b16 v[118:119], v163 offset:10912
    s_waitcnt lgkmcnt(14)
    v_mfma_f32_16x16x32_bf16 v[64:67], v[92:95], v[124:127], v[64:67]
    ds_read_b64_tr_b16 v[120:121], v163 offset:7360
    ds_read_b64_tr_b16 v[122:123], v163 offset:10944
    s_cmp_ge_u32 s91, 5
    s_cbranch_scc1 L_ok3
    s_mov_b32 s70, 0x100000
L_sp3:
    ds_read_b32 v166, v165
    s_sub_u32 s70, s70, 1
    s_cbranch_scc1 L_ok3
    s_waitcnt lgkmcnt(0)
    v_readfirstlane_b32 s91, v166
    s_nop 0
    s_cmp_ge_u32 s91, 5
    s_cbranch_scc1 L_ok3
    s_sleep 1
    s_branch L_sp3
L_ok3:
    ds_read_b64 v[124:125], v136
    ds_read_b64 v[126:127], v137
    s_waitcnt lgkmcnt(14)
    v_mfma_f32_16x16x32_bf16 v[40:43], v[96:99], v[128:131], v[40:43]
    ds_read_b64_tr_b16 v[68:69], v163 offset:14336
    ds_read_b64_tr_b16 v[70:71], v163 offset:17920
    s_waitcnt lgkmcnt(14)
    v_mfma_f32_16x16x32_bf16 v[44:47], v[100:103], v[128:131], v[44:47]
    ds_read_b64_tr_b16 v[72:73], v163 offset:14368
    ds_read_b64_tr_b16 v[74:75], v163 offset:17952
    s_waitcnt lgkmcnt(14)
    v_mfma_f32_16x16x32_bf16 v[48:51], v[104:107], v[128:131], v[48:51]
    ds_read_b64_tr_b16 v[76:77], v163 offset:14400
    ds_read_b64_tr_b16 v[78:79], v163 offset:17984
    s_waitcnt lgkmcnt(14)
    v_mfma_f32_16x16x32_bf16 v[52:55], v[108:111], v[128:131], v[52:55]
    ds_read_b64_tr_b16 v[80:81], v163 offset:14432
    ds_read_b64_tr_b16 v[82:83], v163 offset:18016
    s_waitcnt lgkmcnt(14)
    v_mfma_f32_16x16x32_bf16 v[56:59], v[112:115], v[128:131], v[56:59]
    ds_read_b64_tr_b16 v[84:85], v163 offset:14464
    ds_read_b64_tr_b16 v[86:87], v163 offset:18048
    s_waitcnt lgkmcnt(14)
    v_mfma_f32_16x16x32_bf16 v[60:63], v[116:119], v[128:131], v[60:63]
    ds_read_b64_tr_b16 v[88:89], v163 offset:14496
    ds_read_b64_tr_b16 v[90:91], v163 offset:18080
    s_waitcnt lgkmcnt(14)
    v_mfma_f32_16x16x32_bf16 v[64:67], v[120:123], v[128:131], v[64:67]
    ds_read_b64_tr_b16 v[92:93], v163 offset:14528
    ds_read_b64_tr_b16 v[94:95], v163 offset:18112
    ds_read_b64 v[128:129], v138
    ds_read_b64 v[130:131], v139
    s_waitcnt lgkmcnt(14)
    v_mfma_f32_16x16x32_bf16 v[40:43], v[68:71], v[124:127], v[40:43]
    ds_read_b64_tr_b16 v[96:97], v162 offset:0
    ds_read_b64_tr_b16 v[98:99], v162 offset:3584
    s_waitcnt lgkmcnt(14)
    v_mfma_f32_16x16x32_bf16 v[44:47], v[72:75], v[124:127], v[44:47]
    ds_read_b64_tr_b16 v[100:101], v162 offset:32
    ds_read_b64_tr_b16 v[102:103], v162 offset:3616
    s_waitcnt lgkmcnt(14)
    v_mfma_f32_16x16x32_bf16 v[48:51], v[76:79], v[124:127], v[48:51]
    ds_read_b64_tr_b16 v[104:105], v162 offset:64
    ds_read_b64_tr_b16 v[106:107], v162 offset:3648
    s_waitcnt lgkmcnt(14)
    v_mfma_f32_16x16x32_bf16 v[52:55], v[80:83], v[124:127], v[52:55]
    ds_read_b64_tr_b16 v[108:109], v162 offset:96
    ds_read_b64_tr_b16 v[110:111], v162 offset:3680
    s_waitcnt lgkmcnt(14)
    v_mfma_f32_16x16x32_bf16 v[56:59], v[84:87], v[124:127], v[56:59]
    ds_read_b64_tr_b16 v[112:113], v162 offset:128
    ds_read_b64_tr_b16 v[114:115], v162 offset:3712
    s_waitcnt lgkmcnt(14)
    v_mfma_f32_16x16x32_bf16 v[60:63], v[88:91], v[124:127], v[60:63]
    ds_read_b64_tr_b16 v[116:117], v162 offset:160
    ds_read_b64_tr_b16 v[118:119], v162 offset:3744
    s_waitcnt lgkmcnt(14)
    v_mfma_f32_16x16x32_bf16 v[64:67], v[92:95], v[124:127], v[64:67]
    ds_read_b64_tr_b16 v[120:121], v162 offset:192
    ds_read_b64_tr_b16 v[122:123], v162 offset:3776
    v_mov_b32 v2, 1
    ds_write_b32 v167, v2
    s_cmp_ge_u32 s91, 7
    s_cbranch_scc1 L_ok4
    s_mov_b32 s70, 0x100000
L_sp4:
    ds_read_b32 v166, v165
    s_sub_u32 s70, s70, 1
    s_cbranch_scc1 L_ok4
    s_waitcnt lgkmcnt(0)
    v_readfirstlane_b32 s91, v166
    s_nop 0
    s_cmp_ge_u32 s91, 7
    s_cbranch_scc1 L_ok4
    s_sleep 1
    s_branch L_sp4
L_ok4:
    ds_read_b64 v[124:125], v140
    ds_read_b64 v[126:127], v141
    s_waitcnt lgkmcnt(15)
    v_mfma_f32_16x16x32_bf16 v[40:43], v[96:99], v[128:131], v[40:43]
    ds_read_b64_tr_b16 v[68:69], v162 offset:7168
    ds_read_b64_tr_b16 v[70:71], v162 offset:10752
    s_waitcnt lgkmcnt(15)
    v_mfma_f32_16x16x32_bf16 v[44:47], v[100:103], v[128:131], v[44:47]
    ds_read_b64_tr_b16 v[72:73], v162 offset:7200
    ds_read_b64_tr_b16 v[74:75], v162 offset:10784
    s_waitcnt lgkmcnt(15)
    v_mfma_f32_16x16x32_bf16 v[48:51], v[104:107], v[128:131], v[48:51]
    ds_read_b64_tr_b16 v[76:77], v162 offset:7232
    ds_read_b64_tr_b16 v[78:79], v162 offset:10816
    s_waitcnt lgkmcnt(15)
    v_mfma_f32_16x16x32_bf16 v[52:55], v[108:111], v[128:131], v[52:55]
    ds_read_b64_tr_b16 v[80:81], v162 offset:7264
    ds_read_b64_tr_b16 v[82:83], v162 offset:10848
    s_waitcnt lgkmcnt(15)
    v_mfma_f32_16x16x32_bf16 v[56:59], v[112:115], v[128:131], v[56:59]
    ds_read_b64_tr_b16 v[84:85], v162 offset:7296
    ds_read_b64_tr_b16 v[86:87], v162 offset:10880
    s_waitcnt lgkmcnt(15)
    v_mfma_f32_16x16x32_bf16 v[60:63], v[116:119], v[128:131], v[60:63]
    ds_read_b64_tr_b16 v[88:89], v162 offset:7328
    ds_read_b64_tr_b16 v[90:91], v162 offset:10912
    s_waitcnt lgkmcnt(15)
    v_mfma_f32_16x16x32_bf16 v[64:67], v[120:123], v[128:131], v[64:67]
    ds_read_b64_tr_b16 v[92:93], v162 offset:7360
    ds_read_b64_tr_b16 v[94:95], v162 offset:10944
    ds_read_b64 v[128:129], v142
    ds_read_b64 v[130:131], v143
    s_waitcnt lgkmcnt(14)
    v_mfma_f32_16x16x32_bf16 v[40:43], v[68:71], v[124:127], v[40:43]
    ds_read_b64_tr_b16 v[96:97], v162 offset:14336
    ds_read_b64_tr_b16 v[98:99], v162 offset:17920
    s_waitcnt lgkmcnt(14)
    v_mfma_f32_16x16x32_bf16 v[44:47], v[72:75], v[124:127], v[44:47]
    ds_read_b64_tr_b16 v[100:101], v162 offset:14368
    ds_read_b64_tr_b16 v[102:103], v162 offset:17952
    s_waitcnt lgkmcnt(14)
    v_mfma_f32_16x16x32_bf16 v[48:51], v[76:79], v[124:127], v[48:51]
    ds_read_b64_tr_b16 v[104:105], v162 offset:14400
    ds_read_b64_tr_b16 v[106:107], v162 offset:17984
    s_waitcnt lgkmcnt(14)
    v_mfma_f32_16x16x32_bf16 v[52:55], v[80:83], v[124:127], v[52:55]
    ds_read_b64_tr_b16 v[108:109], v162 offset:14432
    ds_read_b64_tr_b16 v[110:111], v162 offset:18016
    s_waitcnt lgkmcnt(14)
    v_mfma_f32_16x16x32_bf16 v[56:59], v[84:87], v[124:127], v[56:59]
    ds_read_b64_tr_b16 v[112:113], v162 offset:14464
    ds_read_b64_tr_b16 v[114:115], v162 offset:18048
    s_waitcnt lgkmcnt(14)
    v_mfma_f32_16x16x32_bf16 v[60:63], v[88:91], v[124:127], v[60:63]
    ds_read_b64_tr_b16 v[116:117], v162 offset:14496
    ds_read_b64_tr_b16 v[118:119], v162 offset:18080
    s_waitcnt lgkmcnt(14)
    v_mfma_f32_16x16x32_bf16 v[64:67], v[92:95], v[124:127], v[64:67]
    ds_read_b64_tr_b16 v[120:121], v162 offset:14528
    ds_read_b64_tr_b16 v[122:123], v162 offset:18112
    s_cmp_ge_u32 s91, 9
    s_cbranch_scc1 L_ok5
    s_mov_b32 s70, 0x100000
L_sp5:
    ds_read_b32 v166, v165
    s_sub_u32 s70, s70, 1
    s_cbranch_scc1 L_ok5
    s_waitcnt lgkmcnt(0)
    v_readfirstlane_b32 s91, v166
    s_nop 0
    s_cmp_ge_u32 s91, 9
    s_cbranch_scc1 L_ok5
    s_sleep 1
    s_branch L_sp5
L_ok5:
    ds_read_b64 v[124:125], v144
    ds_read_b64 v[126:127], v145
    s_waitcnt lgkmcnt(14)
    v_mfma_f32_16x16x32_bf16 v[40:43], v[96:99], v[128:131], v[40:43]
    ds_read_b64_tr_b16 v[68:69], v162 offset:21504
    ds_read_b64_tr_b16 v[70:71], v162 offset:25088
    s_waitcnt lgkmcnt(14)
    v_mfma_f32_16x16x32_bf16 v[44:47], v[100:103], v[128:131], v[44:47]
    ds_read_b64_tr_b16 v[72:73], v162 offset:21536
    ds_read_b64_tr_b16 v[74:75], v162 offset:25120
    s_waitcnt lgkmcnt(14)
    v_mfma_f32_16x16x32_bf16 v[48:51], v[104:107], v[128:131], v[48:51]
    ds_read_b64_tr_b16 v[76:77], v162 offset:21568
    ds_read_b64_tr_b16 v[78:79], v162 offset:25152
    s_waitcnt lgkmcnt(14)
    v_mfma_f32_16x16x32_bf16 v[52:55], v[108:111], v[128:131], v[52:55]
    ds_read_b64_tr_b16 v[80:81], v162 offset:21600
    ds_read_b64_tr_b16 v[82:83], v162 offset:25184
    s_waitcnt lgkmcnt(14)
    v_mfma_f32_16x16x32_bf16 v[56:59], v[112:115], v[128:131], v[56:59]
    ds_read_b64_tr_b16 v[84:85], v162 offset:21632
    ds_read_b64_tr_b16 v[86:87], v162 offset:25216
    s_waitcnt lgkmcnt(14)
    v_mfma_f32_16x16x32_bf16 v[60:63], v[116:119], v[128:131], v[60:63]
    ds_read_b64_tr_b16 v[88:89], v162 offset:21664
    ds_read_b64_tr_b16 v[90:91], v162 offset:25248
    s_waitcnt lgkmcnt(14)
    v_mfma_f32_16x16x32_bf16 v[64:67], v[120:123], v[128:131], v[64:67]
    ds_read_b64_tr_b16 v[92:93], v162 offset:21696
    ds_read_b64_tr_b16 v[94:95], v162 offset:25280
    ds_read_b64 v[128:129], v146
    ds_read_b64 v[130:131], v147
    s_waitcnt lgkmcnt(14)
    v_mfma_f32_16x16x32_bf16 v[40:43], v[68:71], v[124:127], v[40:43]
    ds_read_b64_tr_b16 v[96:97], v162 offset:28672
    ds_read_b64_tr_b16 v[98:99], v162 offset:32256
    s_waitcnt lgkmcnt(14)
    v_mfma_f32_16x16x32_bf16 v[44:47], v[72:75], v[124:127], v[44:47]
    ds_read_b64_tr_b16 v[100:101], v162 offset:28704
    ds_read_b64_tr_b16 v[102:103], v162 offset:32288
    s_waitcnt lgkmcnt(14)
    v_mfma_f32_16x16x32_bf16 v[48:51], v[76:79], v[124:127], v[48:51]
    ds_read_b64_tr_b16 v[104:105], v162 offset:28736
    ds_read_b64_tr_b16 v[106:107], v162 offset:32320
    s_waitcnt lgkmcnt(14)
    v_mfma_f32_16x16x32_bf16 v[52:55], v[80:83], v[124:127], v[52:55]
    ds_read_b64_tr_b16 v[108:109], v162 offset:28768
    ds_read_b64_tr_b16 v[110:111], v162 offset:32352
    s_waitcnt lgkmcnt(14)
    v_mfma_f32_16x16x32_bf16 v[56:59], v[84:87], v[124:127], v[56:59]
    ds_read_b64_tr_b16 v[112:113], v162 offset:28800
    ds_read_b64_tr_b16 v[114:115], v162 offset:32384
    s_waitcnt lgkmcnt(14)
    v_mfma_f32_16x16x32_bf16 v[60:63], v[88:91], v[124:127], v[60:63]
    ds_read_b64_tr_b16 v[116:117], v162 offset:28832
    ds_read_b64_tr_b16 v[118:119], v162 offset:32416
    s_waitcnt lgkmcnt(14)
    v_mfma_f32_16x16x32_bf16 v[64:67], v[92:95], v[124:127], v[64:67]
    ds_read_b64_tr_b16 v[120:121], v162 offset:28864
    ds_read_b64_tr_b16 v[122:123], v162 offset:32448
    s_cmp_ge_u32 s91, 11
    s_cbranch_scc1 L_ok6
    s_mov_b32 s70, 0x100000
L_sp6:
    ds_read_b32 v166, v165
    s_sub_u32 s70, s70, 1
    s_cbranch_scc1 L_ok6
    s_waitcnt lgkmcnt(0)
    v_readfirstlane_b32 s91, v166
    s_nop 0
    s_cmp_ge_u32 s91, 11
    s_cbranch_scc1 L_ok6
    s_sleep 1
    s_branch L_sp6
L_ok6:
    ds_read_b64 v[124:125], v148
    ds_read_b64 v[126:127], v149
    s_waitcnt lgkmcnt(14)
    v_mfma_f32_16x16x32_bf16 v[40:43], v[96:99], v[128:131], v[40:43]
    ds_read_b64_tr_b16 v[68:69], v162 offset:35840
    ds_read_b64_tr_b16 v[70:71], v162 offset:39424
    s_waitcnt lgkmcnt(14)
    v_mfma_f32_16x16x32_bf16 v[44:47], v[100:103], v[128:131], v[44:47]
    ds_read_b64_tr_b16 v[72:73], v162 offset:35872
    ds_read_b64_tr_b16 v[74:75], v162 offset:39456
    s_waitcnt lgkmcnt(14)
    v_mfma_f32_16x16x32_bf16 v[48:51], v[104:107], v[128:131], v[48:51]
    ds_read_b64_tr_b16 v[76:77], v162 offset:35904
    ds_read_b64_tr_b16 v[78:79], v162 offset:39488
    s_waitcnt lgkmcnt(14)
    v_mfma_f32_16x16x32_bf16 v[52:55], v[108:111], v[128:131], v[52:55]
    ds_read_b64_tr_b16 v[80:81], v162 offset:35936
    ds_read_b64_tr_b16 v[82:83], v162 offset:39520
    s_waitcnt lgkmcnt(14)
    v_mfma_f32_16x16x32_bf16 v[56:59], v[112:115], v[128:131], v[56:59]
    ds_read_b64_tr_b16 v[84:85], v162 offset:35968
    ds_read_b64_tr_b16 v[86:87], v162 offset:39552
    s_waitcnt lgkmcnt(14)
    v_mfma_f32_16x16x32_bf16 v[60:63], v[116:119], v[128:131], v[60:63]
    ds_read_b64_tr_b16 v[88:89], v162 offset:36000
    ds_read_b64_tr_b16 v[90:91], v162 offset:39584
    s_waitcnt lgkmcnt(14)
    v_mfma_f32_16x16x32_bf16 v[64:67], v[120:123], v[128:131], v[64:67]
    ds_read_b64_tr_b16 v[92:93], v162 offset:36032
    ds_read_b64_tr_b16 v[94:95], v162 offset:39616
    v_mov_b32 v2, 2
    ds_write_b32 v167, v2
    ds_read_b64 v[128:129], v150
    ds_read_b64 v[130:131], v151
    s_waitcnt lgkmcnt(15)
    v_mfma_f32_16x16x32_bf16 v[40:43], v[68:71], v[124:127], v[40:43]
    ds_read_b64_tr_b16 v[96:97], v162 offset:43008
    ds_read_b64_tr_b16 v[98:99], v162 offset:46592
    s_waitcnt lgkmcnt(15)
    v_mfma_f32_16x16x32_bf16 v[44:47], v[72:75], v[124:127], v[44:47]
    ds_read_b64_tr_b16 v[100:101], v162 offset:43040
    ds_read_b64_tr_b16 v[102:103], v162 offset:46624
    s_waitcnt lgkmcnt(15)
    v_mfma_f32_16x16x32_bf16 v[48:51], v[76:79], v[124:127], v[48:51]
    ds_read_b64_tr_b16 v[104:105], v162 offset:43072
    ds_read_b64_tr_b16 v[106:107], v162 offset:46656
    s_waitcnt lgkmcnt(15)
    v_mfma_f32_16x16x32_bf16 v[52:55], v[80:83], v[124:127], v[52:55]
    ds_read_b64_tr_b16 v[108:109], v162 offset:43104
    ds_read_b64_tr_b16 v[110:111], v162 offset:46688
    s_waitcnt lgkmcnt(15)
    v_mfma_f32_16x16x32_bf16 v[56:59], v[84:87], v[124:127], v[56:59]
    ds_read_b64_tr_b16 v[112:113], v162 offset:43136
    ds_read_b64_tr_b16 v[114:115], v162 offset:46720
    s_waitcnt lgkmcnt(15)
    v_mfma_f32_16x16x32_bf16 v[60:63], v[88:91], v[124:127], v[60:63]
    ds_read_b64_tr_b16 v[116:117], v162 offset:43168
    ds_read_b64_tr_b16 v[118:119], v162 offset:46752
    s_waitcnt lgkmcnt(15)
    v_mfma_f32_16x16x32_bf16 v[64:67], v[92:95], v[124:127], v[64:67]
    ds_read_b64_tr_b16 v[120:121], v162 offset:43200
    ds_read_b64_tr_b16 v[122:123], v162 offset:46784
    s_cmp_ge_u32 s91, 13
    s_cbranch_scc1 L_ok7
    s_mov_b32 s70, 0x100000
L_sp7:
    ds_read_b32 v166, v165
    s_sub_u32 s70, s70, 1
    s_cbranch_scc1 L_ok7
    s_waitcnt lgkmcnt(0)
    v_readfirstlane_b32 s91, v166
    s_nop 0
    s_cmp_ge_u32 s91, 13
    s_cbranch_scc1 L_ok7
    s_sleep 1
    s_branch L_sp7
L_ok7:
    ds_read_b64 v[124:125], v152
    ds_read_b64 v[126:127], v153
    s_waitcnt lgkmcnt(14)
    v_mfma_f32_16x16x32_bf16 v[40:43], v[96:99], v[128:131], v[40:43]
    ds_read_b64_tr_b16 v[68:69], v162 offset:50176
    ds_read_b64_tr_b16 v[70:71], v162 offset:53760
    s_waitcnt lgkmcnt(14)
    v_mfma_f32_16x16x32_bf16 v[44:47], v[100:103], v[128:131], v[44:47]
    ds_read_b64_tr_b16 v[72:73], v162 offset:50208
    ds_read_b64_tr_b16 v[74:75], v162 offset:53792
    s_waitcnt lgkmcnt(14)
    v_mfma_f32_16x16x32_bf16 v[48:51], v[104:107], v[128:131], v[48:51]
    ds_read_b64_tr_b16 v[76:77], v162 offset:50240
    ds_read_b64_tr_b16 v[78:79], v162 offset:53824
    s_waitcnt lgkmcnt(14)
    v_mfma_f32_16x16x32_bf16 v[52:55], v[108:111], v[128:131], v[52:55]
    ds_read_b64_tr_b16 v[80:81], v162 offset:50272
    ds_read_b64_tr_b16 v[82:83], v162 offset:53856
    s_waitcnt lgkmcnt(14)
    v_mfma_f32_16x16x32_bf16 v[56:59], v[112:115], v[128:131], v[56:59]
    ds_read_b64_tr_b16 v[84:85], v162 offset:50304
    ds_read_b64_tr_b16 v[86:87], v162 offset:53888
    s_waitcnt lgkmcnt(14)
    v_mfma_f32_16x16x32_bf16 v[60:63], v[116:119], v[128:131], v[60:63]
    ds_read_b64_tr_b16 v[88:89], v162 offset:50336
    ds_read_b64_tr_b16 v[90:91], v162 offset:53920
    s_waitcnt lgkmcnt(14)
    v_mfma_f32_16x16x32_bf16 v[64:67], v[120:123], v[128:131], v[64:67]
    ds_read_b64_tr_b16 v[92:93], v162 offset:50368
    ds_read_b64_tr_b16 v[94:95], v162 offset:53952
    ds_read_b64 v[128:129], v154
    ds_read_b64 v[130:131], v155
    v_add_u32 v162, 57344, v162
    s_waitcnt lgkmcnt(14)
    v_mfma_f32_16x16x32_bf16 v[40:43], v[68:71], v[124:127], v[40:43]
    ds_read_b64_tr_b16 v[96:97], v162 offset:0
    ds_read_b64_tr_b16 v[98:99], v162 offset:3584
    s_waitcnt lgkmcnt(14)
    v_mfma_f32_16x16x32_bf16 v[44:47], v[72:75], v[124:127], v[44:47]
    ds_read_b64_tr_b16 v[100:101], v162 offset:32
    ds_read_b64_tr_b16 v[102:103], v162 offset:3616
    s_waitcnt lgkmcnt(14)
    v_mfma_f32_16x16x32_bf16 v[48:51], v[76:79], v[124:127], v[48:51]
    ds_read_b64_tr_b16 v[104:105], v162 offset:64
    ds_read_b64_tr_b16 v[106:107], v162 offset:3648
    s_waitcnt lgkmcnt(14)
    v_mfma_f32_16x16x32_bf16 v[52:55], v[80:83], v[124:127], v[52:55]
    ds_read_b64_tr_b16 v[108:109], v162 offset:96
    ds_read_b64_tr_b16 v[110:111], v162 offset:3680
    s_waitcnt lgkmcnt(14)
    v_mfma_f32_16x16x32_bf16 v[56:59], v[84:87], v[124:127], v[56:59]
    ds_read_b64_tr_b16 v[112:113], v162 offset:128
    ds_read_b64_tr_b16 v[114:115], v162 offset:3712
    s_waitcnt lgkmcnt(14)
    v_mfma_f32_16x16x32_bf16 v[60:63], v[88:91], v[124:127], v[60:63]
    ds_read_b64_tr_b16 v[116:117], v162 offset:160
    ds_read_b64_tr_b16 v[118:119], v162 offset:3744
    s_waitcnt lgkmcnt(14)
    v_mfma_f32_16x16x32_bf16 v[64:67], v[92:95], v[124:127], v[64:67]
    ds_read_b64_tr_b16 v[120:121], v162 offset:192
    ds_read_b64_tr_b16 v[122:123], v162 offset:3776
    s_cmp_ge_u32 s91, 14
    s_cbranch_scc1 L_ok8
    s_mov_b32 s70, 0x100000
L_sp8:
    ds_read_b32 v166, v165
    s_sub_u32 s70, s70, 1
    s_cbranch_scc1 L_ok8
    s_waitcnt lgkmcnt(0)
    v_readfirstlane_b32 s91, v166
    s_nop 0
    s_cmp_ge_u32 s91, 14
    s_cbranch_scc1 L_ok8
    s_sleep 1
    s_branch L_sp8
L_ok8:
    ds_read_b64 v[124:125], v156
    ds_read_b64 v[126:127], v157
    s_waitcnt lgkmcnt(14)
    v_mfma_f32_16x16x32_bf16 v[40:43], v[96:99], v[128:131], v[40:43]
    ds_read_b64_tr_b16 v[68:69], v162 offset:7168
    ds_read_b64_tr_b16 v[70:71], v162 offset:10752
    s_waitcnt lgkmcnt(14)
    v_mfma_f32_16x16x32_bf16 v[44:47], v[100:103], v[128:131], v[44:47]
    ds_read_b64_tr_b16 v[72:73], v162 offset:7200
    ds_read_b64_tr_b16 v[74:75], v162 offset:10784
    s_waitcnt lgkmcnt(14)
    v_mfma_f32_16x16x32_bf16 v[48:51], v[104:107], v[128:131], v[48:51]
    ds_read_b64_tr_b16 v[76:77], v162 offset:7232
    ds_read_b64_tr_b16 v[78:79], v162 offset:10816
    s_waitcnt lgkmcnt(14)
    v_mfma_f32_16x16x32_bf16 v[52:55], v[108:111], v[128:131], v[52:55]
    ds_read_b64_tr_b16 v[80:81], v162 offset:7264
    ds_read_b64_tr_b16 v[82:83], v162 offset:10848
    s_waitcnt lgkmcnt(14)
    v_mfma_f32_16x16x32_bf16 v[56:59], v[112:115], v[128:131], v[56:59]
    ds_read_b64_tr_b16 v[84:85], v162 offset:7296
    ds_read_b64_tr_b16 v[86:87], v162 offset:10880
    s_waitcnt lgkmcnt(14)
    v_mfma_f32_16x16x32_bf16 v[60:63], v[116:119], v[128:131], v[60:63]
    ds_read_b64_tr_b16 v[88:89], v162 offset:7328
    ds_read_b64_tr_b16 v[90:91], v162 offset:10912
    s_waitcnt lgkmcnt(14)
    v_mfma_f32_16x16x32_bf16 v[64:67], v[120:123], v[128:131], v[64:67]
    ds_read_b64_tr_b16 v[92:93], v162 offset:7360
    ds_read_b64_tr_b16 v[94:95], v162 offset:10944
    s_waitcnt lgkmcnt(12)
    v_mfma_f32_16x16x32_bf16 v[40:43], v[68:71], v[124:127], v[40:43]
    s_waitcnt lgkmcnt(10)
    v_mfma_f32_16x16x32_bf16 v[44:47], v[72:75], v[124:127], v[44:47]
    s_waitcnt lgkmcnt(8)
    v_mfma_f32_16x16x32_bf16 v[48:51], v[76:79], v[124:127], v[48:51]
    s_waitcnt lgkmcnt(6)
    v_mfma_f32_16x16x32_bf16 v[52:55], v[80:83], v[124:127], v[52:55]
    s_waitcnt lgkmcnt(4)
    v_mfma_f32_16x16x32_bf16 v[56:59], v[84:87], v[124:127], v[56:59]
    s_waitcnt lgkmcnt(2)
    v_mfma_f32_16x16x32_bf16 v[60:63], v[88:91], v[124:127], v[60:63]
    s_waitcnt lgkmcnt(0)
    v_mfma_f32_16x16x32_bf16 v[64:67], v[92:95], v[124:127], v[64:67]
    v_mov_b32 v2, 3
    ds_write_b32 v167, v2
    s_mov_b32 s80, 0xbdd2d3e8
    ds_read_b64 v[96:97], v164 offset:832
    ds_read_b64 v[98:99], v164 offset:864
    ds_read_b64 v[100:101], v164 offset:896
    ds_read_b64 v[102:103], v164 offset:928
    ds_read_b64 v[104:105], v164 offset:960
    ds_read_b64 v[106:107], v164 offset:992
    ds_read_b64 v[108:109], v164 offset:1024
    v_mov_b32 v125, 0xc0135761
    v_mov_b32 v124, 0
    v_mul_f32 v68, v40, v40
    v_mul_f32 v69, v41, v41
    v_mul_f32 v70, v42, v42
    v_mul_f32 v71, v43, v43
    v_mul_f32 v72, v44, v44
    v_mul_f32 v73, v45, v45
    v_mul_f32 v74, v46, v46
    v_mul_f32 v75, v47, v47
    v_mul_f32 v76, v48, v48
    v_mul_f32 v77, v49, v49
    v_mul_f32 v78, v50, v50
    v_mul_f32 v79, v51, v51
    v_mul_f32 v80, v52, v52
    v_mul_f32 v81, v53, v53
    v_mul_f32 v82, v54, v54
    v_mul_f32 v83, v55, v55
    v_mul_f32 v84, v56, v56
    v_mul_f32 v85, v57, v57
    v_mul_f32 v86, v58, v58
    v_mul_f32 v87, v59, v59
    v_mul_f32 v88, v60, v60
    v_mul_f32 v89, v61, v61
    v_mul_f32 v90, v62, v62
    v_mul_f32 v91, v63, v63
    v_mul_f32 v92, v64, v64
    v_mul_f32 v93, v65, v65
    v_mul_f32 v94, v66, v66
    v_mul_f32 v95, v67, v67
    v_fma_f32 v68, v68, s80, v125
    v_fma_f32 v69, v69, s80, v125
    v_fma_f32 v70, v70, s80, v125
    v_fma_f32 v71, v71, s80, v125
    v_fma_f32 v72, v72, s80, v125
    v_fma_f32 v73, v73, s80, v125
    v_fma_f32 v74, v74, s80, v125
    v_fma_f32 v75, v75, s80, v125
    v_fma_f32 v76, v76, s80, v125
    v_fma_f32 v77, v77, s80, v125
    v_fma_f32 v78, v78, s80, v125
    v_fma_f32 v79, v79, s80, v125
    v_fma_f32 v80, v80, s80, v125
    v_fma_f32 v81, v81, s80, v125
    v_fma_f32 v82, v82, s80, v125
    v_fma_f32 v83, v83, s80, v125
    v_fma_f32 v84, v84, s80, v125
    v_fma_f32 v85, v85, s80, v125
    v_fma_f32 v86, v86, s80, v125
    v_fma_f32 v87, v87, s80, v125
    v_fma_f32 v88, v88, s80, v125
    v_fma_f32 v89, v89, s80, v125
    v_fma_f32 v90, v90, s80, v125
    v_fma_f32 v91, v91, s80, v125
    v_fma_f32 v92, v92, s80, v125
    v_fma_f32 v93, v93, s80, v125
    v_fma_f32 v94, v94, s80, v125
    v_fma_f32 v95, v95, s80, v125
    v_mul_f32 v68, v68, v40
    v_mul_f32 v69, v69, v41
    v_mul_f32 v70, v70, v42
    v_mul_f32 v71, v71, v43
    v_mul_f32 v72, v72, v44
    v_mul_f32 v73, v73, v45
    v_mul_f32 v74, v74, v46
    v_mul_f32 v75, v75, v47
    v_mul_f32 v76, v76, v48
    v_mul_f32 v77, v77, v49
    v_mul_f32 v78, v78, v50
    v_mul_f32 v79, v79, v51
    v_mul_f32 v80, v80, v52
    v_mul_f32 v81, v81, v53
    v_mul_f32 v82, v82, v54
    v_mul_f32 v83, v83, v55
    v_mul_f32 v84, v84, v56
    v_mul_f32 v85, v85, v57
    v_mul_f32 v86, v86, v58
    v_mul_f32 v87, v87, v59
    v_mul_f32 v88, v88, v60
    v_mul_f32 v89, v89, v61
    v_mul_f32 v90, v90, v62
    v_mul_f32 v91, v91, v63
    v_mul_f32 v92, v92, v64
    v_mul_f32 v93, v93, v65
    v_mul_f32 v94, v94, v66
    v_mul_f32 v95, v95, v67
    v_exp_f32 v68, v68
    v_exp_f32 v69, v69
    v_exp_f32 v70, v70
    v_exp_f32 v71, v71
    v_exp_f32 v72, v72
    v_exp_f32 v73, v73
    v_exp_f32 v74, v74
    v_exp_f32 v75, v75
    v_exp_f32 v76, v76
    v_exp_f32 v77, v77
    v_exp_f32 v78, v78
    v_exp_f32 v79, v79
    v_exp_f32 v80, v80
    v_exp_f32 v81, v81
    v_exp_f32 v82, v82
    v_exp_f32 v83, v83
    v_exp_f32 v84, v84
    v_exp_f32 v85, v85
    v_exp_f32 v86, v86
    v_exp_f32 v87, v87
    v_exp_f32 v88, v88
    v_exp_f32 v89, v89
    v_exp_f32 v90, v90
    v_exp_f32 v91, v91
    v_exp_f32 v92, v92
    v_exp_f32 v93, v93
    v_exp_f32 v94, v94
    v_exp_f32 v95, v95
    v_add_f32 v68, 1.0, v68
    v_add_f32 v69, 1.0, v69
    v_add_f32 v70, 1.0, v70
    v_add_f32 v71, 1.0, v71
    v_add_f32 v72, 1.0, v72
    v_add_f32 v73, 1.0, v73
    v_add_f32 v74, 1.0, v74
    v_add_f32 v75, 1.0, v75
    v_add_f32 v76, 1.0, v76
    v_add_f32 v77, 1.0, v77
    v_add_f32 v78, 1.0, v78
    v_add_f32 v79, 1.0, v79
    v_add_f32 v80, 1.0, v80
    v_add_f32 v81, 1.0, v81
    v_add_f32 v82, 1.0, v82
    v_add_f32 v83, 1.0, v83
    v_add_f32 v84, 1.0, v84
    v_add_f32 v85, 1.0, v85
    v_add_f32 v86, 1.0, v86
    v_add_f32 v87, 1.0, v87
    v_add_f32 v88, 1.0, v88
    v_add_f32 v89, 1.0, v89
    v_add_f32 v90, 1.0, v90
    v_add_f32 v91, 1.0, v91
    v_add_f32 v92, 1.0, v92
    v_add_f32 v93, 1.0, v93
    v_add_f32 v94, 1.0, v94
    v_add_f32 v95, 1.0, v95
    v_rcp_f32 v68, v68
    v_rcp_f32 v69, v69
    v_rcp_f32 v70, v70
    v_rcp_f32 v71, v71
    v_rcp_f32 v72, v72
    v_rcp_f32 v73, v73
    v_rcp_f32 v74, v74
    v_rcp_f32 v75, v75
    v_rcp_f32 v76, v76
    v_rcp_f32 v77, v77
    v_rcp_f32 v78, v78
    v_rcp_f32 v79, v79
    v_rcp_f32 v80, v80
    v_rcp_f32 v81, v81
    v_rcp_f32 v82, v82
    v_rcp_f32 v83, v83
    v_rcp_f32 v84, v84
    v_rcp_f32 v85, v85
    v_rcp_f32 v86, v86
    v_rcp_f32 v87, v87
    v_rcp_f32 v88, v88
    v_rcp_f32 v89, v89
    v_rcp_f32 v90, v90
    v_rcp_f32 v91, v91
    v_rcp_f32 v92, v92
    v_rcp_f32 v93, v93
    v_rcp_f32 v94, v94
    v_rcp_f32 v95, v95
    v_mul_f32 v68, v68, v40
    v_mul_f32 v69, v69, v41
    v_mul_f32 v70, v70, v42
    v_mul_f32 v71, v71, v43
    v_mul_f32 v72, v72, v44
    v_mul_f32 v73, v73, v45
    v_mul_f32 v74, v74, v46
    v_mul_f32 v75, v75, v47
    v_mul_f32 v76, v76, v48
    v_mul_f32 v77, v77, v49
    v_mul_f32 v78, v78, v50
    v_mul_f32 v79, v79, v51
    v_mul_f32 v80, v80, v52
    v_mul_f32 v81, v81, v53
    v_mul_f32 v82, v82, v54
    v_mul_f32 v83, v83, v55
    v_mul_f32 v84, v84, v56
    v_mul_f32 v85, v85, v57
    v_mul_f32 v86, v86, v58
    v_mul_f32 v87, v87, v59
    v_mul_f32 v88, v88, v60
    v_mul_f32 v89, v89, v61
    v_mul_f32 v90, v90, v62
    v_mul_f32 v91, v91, v63
    v_mul_f32 v92, v92, v64
    v_mul_f32 v93, v93, v65
    v_mul_f32 v94, v94, v66
    v_mul_f32 v95, v95, v67
    s_waitcnt lgkmcnt(6)
    v_lshlrev_b32 v40, 16, v96
    v_and_b32 v41, 0xffff0000, v96
    v_lshlrev_b32 v42, 16, v97
    v_and_b32 v43, 0xffff0000, v97
    s_waitcnt lgkmcnt(5)
    v_lshlrev_b32 v44, 16, v98
    v_and_b32 v45, 0xffff0000, v98
    v_lshlrev_b32 v46, 16, v99
    v_and_b32 v47, 0xffff0000, v99
    s_waitcnt lgkmcnt(4)
    v_lshlrev_b32 v48, 16, v100
    v_and_b32 v49, 0xffff0000, v100
    v_lshlrev_b32 v50, 16, v101
    v_and_b32 v51, 0xffff0000, v101
    s_waitcnt lgkmcnt(3)
    v_lshlrev_b32 v52, 16, v102
    v_and_b32 v53, 0xffff0000, v102
    v_lshlrev_b32 v54, 16, v103
    v_and_b32 v55, 0xffff0000, v103
    s_waitcnt lgkmcnt(2)
    v_lshlrev_b32 v56, 16, v104
    v_and_b32 v57, 0xffff0000, v104
    v_lshlrev_b32 v58, 16, v105
    v_and_b32 v59, 0xffff0000, v105
    s_waitcnt lgkmcnt(1)
    v_lshlrev_b32 v60, 16, v106
    v_and_b32 v61, 0xffff0000, v106
    v_lshlrev_b32 v62, 16, v107
    v_and_b32 v63, 0xffff0000, v107
    s_waitcnt lgkmcnt(0)
    v_lshlrev_b32 v64, 16, v108
    v_and_b32 v65, 0xffff0000, v108
    v_lshlrev_b32 v66, 16, v109
    v_and_b32 v67, 0xffff0000, v109
    v_fmac_f32 v124, v68, v40
    v_fmac_f32 v124, v69, v41
    v_fmac_f32 v124, v70, v42
    v_fmac_f32 v124, v71, v43
    v_fmac_f32 v124, v72, v44
    v_fmac_f32 v124, v73, v45
    v_fmac_f32 v124, v74, v46
    v_fmac_f32 v124, v75, v47
    v_fmac_f32 v124, v76, v48
    v_fmac_f32 v124, v77, v49
    v_fmac_f32 v124, v78, v50
    v_fmac_f32 v124, v79, v51
    v_fmac_f32 v124, v80, v52
    v_fmac_f32 v124, v81, v53
    v_fmac_f32 v124, v82, v54
    v_fmac_f32 v124, v83, v55
    v_fmac_f32 v124, v84, v56
    v_fmac_f32 v124, v85, v57
    v_fmac_f32 v124, v86, v58
    v_fmac_f32 v124, v87, v59
    v_fmac_f32 v124, v88, v60
    v_fmac_f32 v124, v89, v61
    v_fmac_f32 v124, v90, v62
    v_fmac_f32 v124, v91, v63
    v_fmac_f32 v124, v92, v64
    v_fmac_f32 v124, v93, v65
    v_fmac_f32 v124, v94, v66
    v_fmac_f32 v124, v95, v67
    v_mov_b32 v125, v124
    s_nop 1
    v_permlane16_swap_b32 v124, v125
    v_add_f32 v124, v124, v125
    v_mov_b32 v125, v124
    s_nop 1
    v_permlane32_swap_b32 v124, v125
    v_add_f32 v124, v124, v125
    v_lshlrev_b32 v2, 2, v1
    s_and_b32 s69, s68, 3
    s_lshl_b32 s69, s69, 6
    s_add_u32 s69, s69, 156672
    v_add_u32 v2, s69, v2
    v_mov_b32 v3, 1
    s_mov_b64 exec, 0xffff
    ds_write_b32 v2, v124
    s_mov_b64 exec, 0x1
    ds_add_u32 v165, v3 offset:4
    s_mov_b64 exec, -1
    s_waitcnt lgkmcnt(0)
    s_nop 7
    s_branch L_dnnend
L_dnn0:
    s_cmp_ge_u32 s91, 3
    s_cbranch_scc1 L_ok9
    s_mov_b32 s70, 0x100000
L_sp9:
    ds_read_b32 v166, v165
    s_sub_u32 s70, s70, 1
    s_cbranch_scc1 L_ok9
    s_waitcnt lgkmcnt(0)
    v_readfirstlane_b32 s91, v166
    s_nop 0
    s_cmp_ge_u32 s91, 3
    s_cbranch_scc1 L_ok9
    s_sleep 1
    s_branch L_sp9
L_ok9:
    ds_read_b64 v[124:125], v132
    ds_read_b64 v[126:127], v133
    ds_read_b64_tr_b16 v[72:73], v163 offset:32
    ds_read_b64_tr_b16 v[74:75], v163 offset:3616
    ds_read_b64_tr_b16 v[76:77], v163 offset:64
    ds_read_b64_tr_b16 v[78:79], v163 offset:3648
    ds_read_b64_tr_b16 v[80:81], v163 offset:96
    ds_read_b64_tr_b16 v[82:83], v163 offset:3680
    ds_read_b64_tr_b16 v[84:85], v163 offset:128
    ds_read_b64_tr_b16 v[86:87], v163 offset:3712
    ds_read_b64_tr_b16 v[88:89], v163 offset:160
    ds_read_b64_tr_b16 v[90:91], v163 offset:3744
    ds_read_b64_tr_b16 v[92:93], v163 offset:192
    ds_read_b64_tr_b16 v[94:95], v163 offset:3776
    ds_read_b64 v[128:129], v134
    ds_read_b64 v[130:131], v135
    s_waitcnt lgkmcnt(12)
    v_mfma_f32_16x16x32_bf16 v[44:47], v[72:75], v[124:127], v[44:47]
    ds_read_b64_tr_b16 v[100:101], v163 offset:7200
    ds_read_b64_tr_b16 v[102:103], v163 offset:10784
    s_waitcnt lgkmcnt(12)
    v_mfma_f32_16x16x32_bf16 v[48:51], v[76:79], v[124:127], v[48:51]
    ds_read_b64_tr_b16 v[104:105], v163 offset:7232
    ds_read_b64_tr_b16 v[106:107], v163 offset:10816
    s_waitcnt lgkmcnt(12)
    v_mfma_f32_16x16x32_bf16 v[52:55], v[80:83], v[124:127], v[52:55]
    ds_read_b64_tr_b16 v[108:109], v163 offset:7264
    ds_read_b64_tr_b16 v[110:111], v163 offset:10848
    s_waitcnt lgkmcnt(12)
    v_mfma_f32_16x16x32_bf16 v[56:59], v[84:87], v[124:127], v[56:59]
    ds_read_b64_tr_b16 v[112:113], v163 offset:7296
    ds_read_b64_tr_b16 v[114:115], v163 offset:10880
    s_waitcnt lgkmcnt(12)
    v_mfma_f32_16x16x32_bf16 v[60:63], v[88:91], v[124:127], v[60:63]
    ds_read_b64_tr_b16 v[116:117], v163 offset:7328
    ds_read_b64_tr_b16 v[118:119], v163 offset:10912
    s_waitcnt lgkmcnt(12)
    v_mfma_f32_16x16x32_bf16 v[64:67], v[92:95], v[124:127], v[64:67]
    ds_read_b64_tr_b16 v[120:121], v163 offset:7360
    ds_read_b64_tr_b16 v[122:123], v163 offset:10944
    s_cmp_ge_u32 s91, 5
    s_cbranch_scc1 L_ok10
    s_mov_b32 s70, 0x100000
L_sp10:
    ds_read_b32 v166, v165
    s_sub_u32 s70, s70, 1
    s_cbranch_scc1 L_ok10
    s_waitcnt lgkmcnt(0)
    v_readfirstlane_b32 s91, v166
    s_nop 0
    s_cmp_ge_u32 s91, 5
    s_cbranch_scc1 L_ok10
    s_sleep 1
    s_branch L_sp10
L_ok10:
    ds_read_b64 v[124:125], v136
    ds_read_b64 v[126:127], v137
    s_waitcnt lgkmcnt(12)
    v_mfma_f32_16x16x32_bf16 v[44:47], v[100:103], v[128:131], v[44:47]
    ds_read_b64_tr_b16 v[72:73], v163 offset:14368
    ds_read_b64_tr_b16 v[74:75], v163 offset:17952
    s_waitcnt lgkmcnt(12)
    v_mfma_f32_16x16x32_bf16 v[48:51], v[104:107], v[128:131], v[48:51]
    ds_read_b64_tr_b16 v[76:77], v163 offset:14400
    ds_read_b64_tr_b16 v[78:79], v163 offset:17984
    s_waitcnt lgkmcnt(12)
    v_mfma_f32_16x16x32_bf16 v[52:55], v[108:111], v[128:131], v[52:55]
    ds_read_b64_tr_b16 v[80:81], v163 offset:14432
    ds_read_b64_tr_b16 v[82:83], v163 offset:18016
    s_waitcnt lgkmcnt(12)
    v_mfma_f32_16x16x32_bf16 v[56:59], v[112:115], v[128:131], v[56:59]
    ds_read_b64_tr_b16 v[84:85], v163 offset:14464
    ds_read_b64_tr_b16 v[86:87], v163 offset:18048
    s_waitcnt lgkmcnt(12)
    v_mfma_f32_16x16x32_bf16 v[60:63], v[116:119], v[128:131], v[60:63]
    ds_read_b64_tr_b16 v[88:89], v163 offset:14496
    ds_read_b64_tr_b16 v[90:91], v163 offset:18080
    s_waitcnt lgkmcnt(12)
    v_mfma_f32_16x16x32_bf16 v[64:67], v[120:123], v[128:131], v[64:67]
    ds_read_b64_tr_b16 v[92:93], v163 offset:14528
    ds_read_b64_tr_b16 v[94:95], v163 offset:18112
    ds_read_b64 v[128:129], v138
    ds_read_b64 v[130:131], v139
    s_waitcnt lgkmcnt(12)
    v_mfma_f32_16x16x32_bf16 v[44:47], v[72:75], v[124:127], v[44:47]
    ds_read_b64_tr_b16 v[100:101], v162 offset:32
    ds_read_b64_tr_b16 v[102:103], v162 offset:3616
    s_waitcnt lgkmcnt(12)
    v_mfma_f32_16x16x32_bf16 v[48:51], v[76:79], v[124:127], v[48:51]
    ds_read_b64_tr_b16 v[104:105], v162 offset:64
    ds_read_b64_tr_b16 v[106:107], v162 offset:3648
    s_waitcnt lgkmcnt(12)
    v_mfma_f32_16x16x32_bf16 v[52:55], v[80:83], v[124:127], v[52:55]
    ds_read_b64_tr_b16 v[108:109], v162 offset:96
    ds_read_b64_tr_b16 v[110:111], v162 offset:3680
    s_waitcnt lgkmcnt(12)
    v_mfma_f32_16x16x32_bf16 v[56:59], v[84:87], v[124:127], v[56:59]
    ds_read_b64_tr_b16 v[112:113], v162 offset:128
    ds_read_b64_tr_b16 v[114:115], v162 offset:3712
    s_waitcnt lgkmcnt(12)
    v_mfma_f32_16x16x32_bf16 v[60:63], v[88:91], v[124:127], v[60:63]
    ds_read_b64_tr_b16 v[116:117], v162 offset:160
    ds_read_b64_tr_b16 v[118:119], v162 offset:3744
    s_waitcnt lgkmcnt(12)
    v_mfma_f32_16x16x32_bf16 v[64:67], v[92:95], v[124:127], v[64:67]
    ds_read_b64_tr_b16 v[120:121], v162 offset:192
    ds_read_b64_tr_b16 v[122:123], v162 offset:3776
    v_mov_b32 v2, 1
    ds_write_b32 v167, v2
    s_cmp_ge_u32 s91, 7
    s_cbranch_scc1 L_ok11
    s_mov_b32 s70, 0x100000
L_sp11:
    ds_read_b32 v166, v165
    s_sub_u32 s70, s70, 1
    s_cbranch_scc1 L_ok11
    s_waitcnt lgkmcnt(0)
    v_readfirstlane_b32 s91, v166
    s_nop 0
    s_cmp_ge_u32 s91, 7
    s_cbranch_scc1 L_ok11
    s_sleep 1
    s_branch L_sp11
L_ok11:
    ds_read_b64 v[124:125], v140
    ds_read_b64 v[126:127], v141
    s_waitcnt lgkmcnt(13)
    v_mfma_f32_16x16x32_bf16 v[44:47], v[100:103], v[128:131], v[44:47]
    ds_read_b64_tr_b16 v[72:73], v162 offset:7200
    ds_read_b64_tr_b16 v[74:75], v162 offset:10784
    s_waitcnt lgkmcnt(13)
    v_mfma_f32_16x16x32_bf16 v[48:51], v[104:107], v[128:131], v[48:51]
    ds_read_b64_tr_b16 v[76:77], v162 offset:7232
    ds_read_b64_tr_b16 v[78:79], v162 offset:10816
    s_waitcnt lgkmcnt(13)
    v_mfma_f32_16x16x32_bf16 v[52:55], v[108:111], v[128:131], v[52:55]
    ds_read_b64_tr_b16 v[80:81], v162 offset:7264
    ds_read_b64_tr_b16 v[82:83], v162 offset:10848
    s_waitcnt lgkmcnt(13)
    v_mfma_f32_16x16x32_bf16 v[56:59], v[112:115], v[128:131], v[56:59]
    ds_read_b64_tr_b16 v[84:85], v162 offset:7296
    ds_read_b64_tr_b16 v[86:87], v162 offset:10880
    s_waitcnt lgkmcnt(13)
    v_mfma_f32_16x16x32_bf16 v[60:63], v[116:119], v[128:131], v[60:63]
    ds_read_b64_tr_b16 v[88:89], v162 offset:7328
    ds_read_b64_tr_b16 v[90:91], v162 offset:10912
    s_waitcnt lgkmcnt(13)
    v_mfma_f32_16x16x32_bf16 v[64:67], v[120:123], v[128:131], v[64:67]
    ds_read_b64_tr_b16 v[92:93], v162 offset:7360
    ds_read_b64_tr_b16 v[94:95], v162 offset:10944
    ds_read_b64 v[128:129], v142
    ds_read_b64 v[130:131], v143
    s_waitcnt lgkmcnt(12)
    v_mfma_f32_16x16x32_bf16 v[44:47], v[72:75], v[124:127], v[44:47]
    ds_read_b64_tr_b16 v[100:101], v162 offset:14368
    ds_read_b64_tr_b16 v[102:103], v162 offset:17952
    s_waitcnt lgkmcnt(12)
    v_mfma_f32_16x16x32_bf16 v[48:51], v[76:79], v[124:127], v[48:51]
    ds_read_b64_tr_b16 v[104:105], v162 offset:14400
    ds_read_b64_tr_b16 v[106:107], v162 offset:17984
    s_waitcnt lgkmcnt(12)
    v_mfma_f32_16x16x32_bf16 v[52:55], v[80:83], v[124:127], v[52:55]
    ds_read_b64_tr_b16 v[108:109], v162 offset:14432
    ds_read_b64_tr_b16 v[110:111], v162 offset:18016
    s_waitcnt lgkmcnt(12)
    v_mfma_f32_16x16x32_bf16 v[56:59], v[84:87], v[124:127], v[56:59]
    ds_read_b64_tr_b16 v[112:113], v162 offset:14464
    ds_read_b64_tr_b16 v[114:115], v162 offset:18048
    s_waitcnt lgkmcnt(12)
    v_mfma_f32_16x16x32_bf16 v[60:63], v[88:91], v[124:127], v[60:63]
    ds_read_b64_tr_b16 v[116:117], v162 offset:14496
    ds_read_b64_tr_b16 v[118:119], v162 offset:18080
    s_waitcnt lgkmcnt(12)
    v_mfma_f32_16x16x32_bf16 v[64:67], v[92:95], v[124:127], v[64:67]
    ds_read_b64_tr_b16 v[120:121], v162 offset:14528
    ds_read_b64_tr_b16 v[122:123], v162 offset:18112
    s_cmp_ge_u32 s91, 9
    s_cbranch_scc1 L_ok12
    s_mov_b32 s70, 0x100000
L_sp12:
    ds_read_b32 v166, v165
    s_sub_u32 s70, s70, 1
    s_cbranch_scc1 L_ok12
    s_waitcnt lgkmcnt(0)
    v_readfirstlane_b32 s91, v166
    s_nop 0
    s_cmp_ge_u32 s91, 9
    s_cbranch_scc1 L_ok12
    s_sleep 1
    s_branch L_sp12
L_ok12:
    ds_read_b64 v[124:125], v144
    ds_read_b64 v[126:127], v145
    s_waitcnt lgkmcnt(12)
    v_mfma_f32_16x16x32_bf16 v[44:47], v[100:103], v[128:131], v[44:47]
    ds_read_b64_tr_b16 v[72:73], v162 offset:21536
    ds_read_b64_tr_b16 v[74:75], v162 offset:25120
    s_waitcnt lgkmcnt(12)
    v_mfma_f32_16x16x32_bf16 v[48:51], v[104:107], v[128:131], v[48:51]
    ds_read_b64_tr_b16 v[76:77], v162 offset:21568
    ds_read_b64_tr_b16 v[78:79], v162 offset:25152
    s_waitcnt lgkmcnt(12)
    v_mfma_f32_16x16x32_bf16 v[52:55], v[108:111], v[128:131], v[52:55]
    ds_read_b64_tr_b16 v[80:81], v162 offset:21600
    ds_read_b64_tr_b16 v[82:83], v162 offset:25184
    s_waitcnt lgkmcnt(12)
    v_mfma_f32_16x16x32_bf16 v[56:59], v[112:115], v[128:131], v[56:59]
    ds_read_b64_tr_b16 v[84:85], v162 offset:21632
    ds_read_b64_tr_b16 v[86:87], v162 offset:25216
    s_waitcnt lgkmcnt(12)
    v_mfma_f32_16x16x32_bf16 v[60:63], v[116:119], v[128:131], v[60:63]
    ds_read_b64_tr_b16 v[88:89], v162 offset:21664
    ds_read_b64_tr_b16 v[90:91], v162 offset:25248
    s_waitcnt lgkmcnt(12)
    v_mfma_f32_16x16x32_bf16 v[64:67], v[120:123], v[128:131], v[64:67]
    ds_read_b64_tr_b16 v[92:93], v162 offset:21696
    ds_read_b64_tr_b16 v[94:95], v162 offset:25280
    ds_read_b64 v[128:129], v146
    ds_read_b64 v[130:131], v147
    s_waitcnt lgkmcnt(12)
    v_mfma_f32_16x16x32_bf16 v[44:47], v[72:75], v[124:127], v[44:47]
    ds_read_b64_tr_b16 v[100:101], v162 offset:28704
    ds_read_b64_tr_b16 v[102:103], v162 offset:32288
    s_waitcnt lgkmcnt(12)
    v_mfma_f32_16x16x32_bf16 v[48:51], v[76:79], v[124:127], v[48:51]
    ds_read_b64_tr_b16 v[104:105], v162 offset:28736
    ds_read_b64_tr_b16 v[106:107], v162 offset:32320
    s_waitcnt lgkmcnt(12)
    v_mfma_f32_16x16x32_bf16 v[52:55], v[80:83], v[124:127], v[52:55]
    ds_read_b64_tr_b16 v[108:109], v162 offset:28768
    ds_read_b64_tr_b16 v[110:111], v162 offset:32352
    s_waitcnt lgkmcnt(12)
    v_mfma_f32_16x16x32_bf16 v[56:59], v[84:87], v[124:127], v[56:59]
    ds_read_b64_tr_b16 v[112:113], v162 offset:28800
    ds_read_b64_tr_b16 v[114:115], v162 offset:32384
    s_waitcnt lgkmcnt(12)
    v_mfma_f32_16x16x32_bf16 v[60:63], v[88:91], v[124:127], v[60:63]
    ds_read_b64_tr_b16 v[116:117], v162 offset:28832
    ds_read_b64_tr_b16 v[118:119], v162 offset:32416
    s_waitcnt lgkmcnt(12)
    v_mfma_f32_16x16x32_bf16 v[64:67], v[92:95], v[124:127], v[64:67]
    ds_read_b64_tr_b16 v[120:121], v162 offset:28864
    ds_read_b64_tr_b16 v[122:123], v162 offset:32448
    s_cmp_ge_u32 s91, 11
    s_cbranch_scc1 L_ok13
    s_mov_b32 s70, 0x100000
L_sp13:
    ds_read_b32 v166, v165
    s_sub_u32 s70, s70, 1
    s_cbranch_scc1 L_ok13
    s_waitcnt lgkmcnt(0)
    v_readfirstlane_b32 s91, v166
    s_nop 0
    s_cmp_ge_u32 s91, 11
    s_cbranch_scc1 L_ok13
    s_sleep 1
    s_branch L_sp13
L_ok13:
    ds_read_b64 v[124:125], v148
    ds_read_b64 v[126:127], v149
    s_waitcnt lgkmcnt(12)
    v_mfma_f32_16x16x32_bf16 v[44:47], v[100:103], v[128:131], v[44:47]
    ds_read_b64_tr_b16 v[72:73], v162 offset:35872
    ds_read_b64_tr_b16 v[74:75], v162 offset:39456
    s_waitcnt lgkmcnt(12)
    v_mfma_f32_16x16x32_bf16 v[48:51], v[104:107], v[128:131], v[48:51]
    ds_read_b64_tr_b16 v[76:77], v162 offset:35904
    ds_read_b64_tr_b16 v[78:79], v162 offset:39488
    s_waitcnt lgkmcnt(12)
    v_mfma_f32_16x16x32_bf16 v[52:55], v[108:111], v[128:131], v[52:55]
    ds_read_b64_tr_b16 v[80:81], v162 offset:35936
    ds_read_b64_tr_b16 v[82:83], v162 offset:39520
    s_waitcnt lgkmcnt(12)
    v_mfma_f32_16x16x32_bf16 v[56:59], v[112:115], v[128:131], v[56:59]
    ds_read_b64_tr_b16 v[84:85], v162 offset:35968
    ds_read_b64_tr_b16 v[86:87], v162 offset:39552
    s_waitcnt lgkmcnt(12)
    v_mfma_f32_16x16x32_bf16 v[60:63], v[116:119], v[128:131], v[60:63]
    ds_read_b64_tr_b16 v[88:89], v162 offset:36000
    ds_read_b64_tr_b16 v[90:91], v162 offset:39584
    s_waitcnt lgkmcnt(12)
    v_mfma_f32_16x16x32_bf16 v[64:67], v[120:123], v[128:131], v[64:67]
    ds_read_b64_tr_b16 v[92:93], v162 offset:36032
    ds_read_b64_tr_b16 v[94:95], v162 offset:39616
    v_mov_b32 v2, 2
    ds_write_b32 v167, v2
    ds_read_b64 v[128:129], v150
    ds_read_b64 v[130:131], v151
    s_waitcnt lgkmcnt(13)
    v_mfma_f32_16x16x32_bf16 v[44:47], v[72:75], v[124:127], v[44:47]
    ds_read_b64_tr_b16 v[100:101], v162 offset:43040
    ds_read_b64_tr_b16 v[102:103], v162 offset:46624
    s_waitcnt lgkmcnt(13)
    v_mfma_f32_16x16x32_bf16 v[48:51], v[76:79], v[124:127], v[48:51]
    ds_read_b64_tr_b16 v[104:105], v162 offset:43072
    ds_read_b64_tr_b16 v[106:107], v162 offset:46656
    s_waitcnt lgkmcnt(13)
    v_mfma_f32_16x16x32_bf16 v[52:55], v[80:83], v[124:127], v[52:55]
    ds_read_b64_tr_b16 v[108:109], v162 offset:43104
    ds_read_b64_tr_b16 v[110:111], v162 offset:46688
    s_waitcnt lgkmcnt(13)
    v_mfma_f32_16x16x32_bf16 v[56:59], v[84:87], v[124:127], v[56:59]
    ds_read_b64_tr_b16 v[112:113], v162 offset:43136
    ds_read_b64_tr_b16 v[114:115], v162 offset:46720
    s_waitcnt lgkmcnt(13)
    v_mfma_f32_16x16x32_bf16 v[60:63], v[88:91], v[124:127], v[60:63]
    ds_read_b64_tr_b16 v[116:117], v162 offset:43168
    ds_read_b64_tr_b16 v[118:119], v162 offset:46752
    s_waitcnt lgkmcnt(13)
    v_mfma_f32_16x16x32_bf16 v[64:67], v[92:95], v[124:127], v[64:67]
    ds_read_b64_tr_b16 v[120:121], v162 offset:43200
    ds_read_b64_tr_b16 v[122:123], v162 offset:46784
    s_cmp_ge_u32 s91, 13
    s_cbranch_scc1 L_ok14
    s_mov_b32 s70, 0x100000
L_sp14:
    ds_read_b32 v166, v165
    s_sub_u32 s70, s70, 1
    s_cbranch_scc1 L_ok14
    s_waitcnt lgkmcnt(0)
    v_readfirstlane_b32 s91, v166
    s_nop 0
    s_cmp_ge_u32 s91, 13
    s_cbranch_scc1 L_ok14
    s_sleep 1
    s_branch L_sp14
L_ok14:
    ds_read_b64 v[124:125], v152
    ds_read_b64 v[126:127], v153
    s_waitcnt lgkmcnt(12)
    v_mfma_f32_16x16x32_bf16 v[44:47], v[100:103], v[128:131], v[44:47]
    ds_read_b64_tr_b16 v[72:73], v162 offset:50208
    ds_read_b64_tr_b16 v[74:75], v162 offset:53792
    s_waitcnt lgkmcnt(12)
    v_mfma_f32_16x16x32_bf16 v[48:51], v[104:107], v[128:131], v[48:51]
    ds_read_b64_tr_b16 v[76:77], v162 offset:50240
    ds_read_b64_tr_b16 v[78:79], v162 offset:53824
    s_waitcnt lgkmcnt(12)
    v_mfma_f32_16x16x32_bf16 v[52:55], v[108:111], v[128:131], v[52:55]
    ds_read_b64_tr_b16 v[80:81], v162 offset:50272
    ds_read_b64_tr_b16 v[82:83], v162 offset:53856
    s_waitcnt lgkmcnt(12)
    v_mfma_f32_16x16x32_bf16 v[56:59], v[112:115], v[128:131], v[56:59]
    ds_read_b64_tr_b16 v[84:85], v162 offset:50304
    ds_read_b64_tr_b16 v[86:87], v162 offset:53888
    s_waitcnt lgkmcnt(12)
    v_mfma_f32_16x16x32_bf16 v[60:63], v[116:119], v[128:131], v[60:63]
    ds_read_b64_tr_b16 v[88:89], v162 offset:50336
    ds_read_b64_tr_b16 v[90:91], v162 offset:53920
    s_waitcnt lgkmcnt(12)
    v_mfma_f32_16x16x32_bf16 v[64:67], v[120:123], v[128:131], v[64:67]
    ds_read_b64_tr_b16 v[92:93], v162 offset:50368
    ds_read_b64_tr_b16 v[94:95], v162 offset:53952
    ds_read_b64 v[128:129], v154
    ds_read_b64 v[130:131], v155
    v_add_u32 v162, 57344, v162
    s_waitcnt lgkmcnt(12)
    v_mfma_f32_16x16x32_bf16 v[44:47], v[72:75], v[124:127], v[44:47]
    ds_read_b64_tr_b16 v[100:101], v162 offset:32
    ds_read_b64_tr_b16 v[102:103], v162 offset:3616
    s_waitcnt lgkmcnt(12)
    v_mfma_f32_16x16x32_bf16 v[48:51], v[76:79], v[124:127], v[48:51]
    ds_read_b64_tr_b16 v[104:105], v162 offset:64
    ds_read_b64_tr_b16 v[106:107], v162 offset:3648
    s_waitcnt lgkmcnt(12)
    v_mfma_f32_16x16x32_bf16 v[52:55], v[80:83], v[124:127], v[52:55]
    ds_read_b64_tr_b16 v[108:109], v162 offset:96
    ds_read_b64_tr_b16 v[110:111], v162 offset:3680
    s_waitcnt lgkmcnt(12)
    v_mfma_f32_16x16x32_bf16 v[56:59], v[84:87], v[124:127], v[56:59]
    ds_read_b64_tr_b16 v[112:113], v162 offset:128
    ds_read_b64_tr_b16 v[114:115], v162 offset:3712
    s_waitcnt lgkmcnt(12)
    v_mfma_f32_16x16x32_bf16 v[60:63], v[88:91], v[124:127], v[60:63]
    ds_read_b64_tr_b16 v[116:117], v162 offset:160
    ds_read_b64_tr_b16 v[118:119], v162 offset:3744
    s_waitcnt lgkmcnt(12)
    v_mfma_f32_16x16x32_bf16 v[64:67], v[92:95], v[124:127], v[64:67]
    ds_read_b64_tr_b16 v[120:121], v162 offset:192
    ds_read_b64_tr_b16 v[122:123], v162 offset:3776
    s_cmp_ge_u32 s91, 14
    s_cbranch_scc1 L_ok15
    s_mov_b32 s70, 0x100000
L_sp15:
    ds_read_b32 v166, v165
    s_sub_u32 s70, s70, 1
    s_cbranch_scc1 L_ok15
    s_waitcnt lgkmcnt(0)
    v_readfirstlane_b32 s91, v166
    s_nop 0
    s_cmp_ge_u32 s91, 14
    s_cbranch_scc1 L_ok15
    s_sleep 1
    s_branch L_sp15
L_ok15:
    ds_read_b64 v[124:125], v156
    ds_read_b64 v[126:127], v157
    s_waitcnt lgkmcnt(12)
    v_mfma_f32_16x16x32_bf16 v[44:47], v[100:103], v[128:131], v[44:47]
    ds_read_b64_tr_b16 v[72:73], v162 offset:7200
    ds_read_b64_tr_b16 v[74:75], v162 offset:10784
    s_waitcnt lgkmcnt(12)
    v_mfma_f32_16x16x32_bf16 v[48:51], v[104:107], v[128:131], v[48:51]
    ds_read_b64_tr_b16 v[76:77], v162 offset:7232
    ds_read_b64_tr_b16 v[78:79], v162 offset:10816
    s_waitcnt lgkmcnt(12)
    v_mfma_f32_16x16x32_bf16 v[52:55], v[108:111], v[128:131], v[52:55]
    ds_read_b64_tr_b16 v[80:81], v162 offset:7264
    ds_read_b64_tr_b16 v[82:83], v162 offset:10848
    s_waitcnt lgkmcnt(12)
    v_mfma_f32_16x16x32_bf16 v[56:59], v[112:115], v[128:131], v[56:59]
    ds_read_b64_tr_b16 v[84:85], v162 offset:7296
    ds_read_b64_tr_b16 v[86:87], v162 offset:10880
    s_waitcnt lgkmcnt(12)
    v_mfma_f32_16x16x32_bf16 v[60:63], v[116:119], v[128:131], v[60:63]
    ds_read_b64_tr_b16 v[88:89], v162 offset:7328
    ds_read_b64_tr_b16 v[90:91], v162 offset:10912
    s_waitcnt lgkmcnt(12)
    v_mfma_f32_16x16x32_bf16 v[64:67], v[120:123], v[128:131], v[64:67]
    ds_read_b64_tr_b16 v[92:93], v162 offset:7360
    ds_read_b64_tr_b16 v[94:95], v162 offset:10944
    s_waitcnt lgkmcnt(10)
    v_mfma_f32_16x16x32_bf16 v[44:47], v[72:75], v[124:127], v[44:47]
    s_waitcnt lgkmcnt(8)
    v_mfma_f32_16x16x32_bf16 v[48:51], v[76:79], v[124:127], v[48:51]
    s_waitcnt lgkmcnt(6)
    v_mfma_f32_16x16x32_bf16 v[52:55], v[80:83], v[124:127], v[52:55]
    s_waitcnt lgkmcnt(4)
    v_mfma_f32_16x16x32_bf16 v[56:59], v[84:87], v[124:127], v[56:59]
    s_waitcnt lgkmcnt(2)
    v_mfma_f32_16x16x32_bf16 v[60:63], v[88:91], v[124:127], v[60:63]
    s_waitcnt lgkmcnt(0)
    v_mfma_f32_16x16x32_bf16 v[64:67], v[92:95], v[124:127], v[64:67]
    v_mov_b32 v2, 3
    ds_write_b32 v167, v2
    s_mov_b32 s80, 0xbdd2d3e8
    ds_read_b64 v[98:99], v164 offset:864
    ds_read_b64 v[100:101], v164 offset:896
    ds_read_b64 v[102:103], v164 offset:928
    ds_read_b64 v[104:105], v164 offset:960
    ds_read_b64 v[106:107], v164 offset:992
    ds_read_b64 v[108:109], v164 offset:1024
    v_mov_b32 v125, 0xc0135761
    v_mov_b32 v124, 0
    v_mul_f32 v72, v44, v44
    v_mul_f32 v73, v45, v45
    v_mul_f32 v74, v46, v46
    v_mul_f32 v75, v47, v47
    v_mul_f32 v76, v48, v48
    v_mul_f32 v77, v49, v49
    v_mul_f32 v78, v50, v50
    v_mul_f32 v79, v51, v51
    v_mul_f32 v80, v52, v52
    v_mul_f32 v81, v53, v53
    v_mul_f32 v82, v54, v54
    v_mul_f32 v83, v55, v55
    v_mul_f32 v84, v56, v56
    v_mul_f32 v85, v57, v57
    v_mul_f32 v86, v58, v58
    v_mul_f32 v87, v59, v59
    v_mul_f32 v88, v60, v60
    v_mul_f32 v89, v61, v61
    v_mul_f32 v90, v62, v62
    v_mul_f32 v91, v63, v63
    v_mul_f32 v92, v64, v64
    v_mul_f32 v93, v65, v65
    v_mul_f32 v94, v66, v66
    v_mul_f32 v95, v67, v67
    v_fma_f32 v72, v72, s80, v125
    v_fma_f32 v73, v73, s80, v125
    v_fma_f32 v74, v74, s80, v125
    v_fma_f32 v75, v75, s80, v125
    v_fma_f32 v76, v76, s80, v125
    v_fma_f32 v77, v77, s80, v125
    v_fma_f32 v78, v78, s80, v125
    v_fma_f32 v79, v79, s80, v125
    v_fma_f32 v80, v80, s80, v125
    v_fma_f32 v81, v81, s80, v125
    v_fma_f32 v82, v82, s80, v125
    v_fma_f32 v83, v83, s80, v125
    v_fma_f32 v84, v84, s80, v125
    v_fma_f32 v85, v85, s80, v125
    v_fma_f32 v86, v86, s80, v125
    v_fma_f32 v87, v87, s80, v125
    v_fma_f32 v88, v88, s80, v125
    v_fma_f32 v89, v89, s80, v125
    v_fma_f32 v90, v90, s80, v125
    v_fma_f32 v91, v91, s80, v125
    v_fma_f32 v92, v92, s80, v125
    v_fma_f32 v93, v93, s80, v125
    v_fma_f32 v94, v94, s80, v125
    v_fma_f32 v95, v95, s80, v125
    v_mul_f32 v72, v72, v44
    v_mul_f32 v73, v73, v45
    v_mul_f32 v74, v74, v46
    v_mul_f32 v75, v75, v47
    v_mul_f32 v76, v76, v48
    v_mul_f32 v77, v77, v49
    v_mul_f32 v78, v78, v50
    v_mul_f32 v79, v79, v51
    v_mul_f32 v80, v80, v52
    v_mul_f32 v81, v81, v53
    v_mul_f32 v82, v82, v54
    v_mul_f32 v83, v83, v55
    v_mul_f32 v84, v84, v56
    v_mul_f32 v85, v85, v57
    v_mul_f32 v86, v86, v58
    v_mul_f32 v87, v87, v59
    v_mul_f32 v88, v88, v60
    v_mul_f32 v89, v89, v61
    v_mul_f32 v90, v90, v62
    v_mul_f32 v91, v91, v63
    v_mul_f32 v92, v92, v64
    v_mul_f32 v93, v93, v65
    v_mul_f32 v94, v94, v66
    v_mul_f32 v95, v95, v67
    v_exp_f32 v72, v72
    v_exp_f32 v73, v73
    v_exp_f32 v74, v74
    v_exp_f32 v75, v75
    v_exp_f32 v76, v76
    v_exp_f32 v77, v77
    v_exp_f32 v78, v78
    v_exp_f32 v79, v79
    v_exp_f32 v80, v80
    v_exp_f32 v81, v81
    v_exp_f32 v82, v82
    v_exp_f32 v83, v83
    v_exp_f32 v84, v84
    v_exp_f32 v85, v85
    v_exp_f32 v86, v86
    v_exp_f32 v87, v87
    v_exp_f32 v88, v88
    v_exp_f32 v89, v89
    v_exp_f32 v90, v90
    v_exp_f32 v91, v91
    v_exp_f32 v92, v92
    v_exp_f32 v93, v93
    v_exp_f32 v94, v94
    v_exp_f32 v95, v95
    v_add_f32 v72, 1.0, v72
    v_add_f32 v73, 1.0, v73
    v_add_f32 v74, 1.0, v74
    v_add_f32 v75, 1.0, v75
    v_add_f32 v76, 1.0, v76
    v_add_f32 v77, 1.0, v77
    v_add_f32 v78, 1.0, v78
    v_add_f32 v79, 1.0, v79
    v_add_f32 v80, 1.0, v80
    v_add_f32 v81, 1.0, v81
    v_add_f32 v82, 1.0, v82
    v_add_f32 v83, 1.0, v83
    v_add_f32 v84, 1.0, v84
    v_add_f32 v85, 1.0, v85
    v_add_f32 v86, 1.0, v86
    v_add_f32 v87, 1.0, v87
    v_add_f32 v88, 1.0, v88
    v_add_f32 v89, 1.0, v89
    v_add_f32 v90, 1.0, v90
    v_add_f32 v91, 1.0, v91
    v_add_f32 v92, 1.0, v92
    v_add_f32 v93, 1.0, v93
    v_add_f32 v94, 1.0, v94
    v_add_f32 v95, 1.0, v95
    v_rcp_f32 v72, v72
    v_rcp_f32 v73, v73
    v_rcp_f32 v74, v74
    v_rcp_f32 v75, v75
    v_rcp_f32 v76, v76
    v_rcp_f32 v77, v77
    v_rcp_f32 v78, v78
    v_rcp_f32 v79, v79
    v_rcp_f32 v80, v80
    v_rcp_f32 v81, v81
    v_rcp_f32 v82, v82
    v_rcp_f32 v83, v83
    v_rcp_f32 v84, v84
    v_rcp_f32 v85, v85
    v_rcp_f32 v86, v86
    v_rcp_f32 v87, v87
    v_rcp_f32 v88, v88
    v_rcp_f32 v89, v89
    v_rcp_f32 v90, v90
    v_rcp_f32 v91, v91
    v_rcp_f32 v92, v92
    v_rcp_f32 v93, v93
    v_rcp_f32 v94, v94
    v_rcp_f32 v95, v95
    v_mul_f32 v72, v72, v44
    v_mul_f32 v73, v73, v45
    v_mul_f32 v74, v74, v46
    v_mul_f32 v75, v75, v47
    v_mul_f32 v76, v76, v48
    v_mul_f32 v77, v77, v49
    v_mul_f32 v78, v78, v50
    v_mul_f32 v79, v79, v51
    v_mul_f32 v80, v80, v52
    v_mul_f32 v81, v81, v53
    v_mul_f32 v82, v82, v54
    v_mul_f32 v83, v83, v55
    v_mul_f32 v84, v84, v56
    v_mul_f32 v85, v85, v57
    v_mul_f32 v86, v86, v58
    v_mul_f32 v87, v87, v59
    v_mul_f32 v88, v88, v60
    v_mul_f32 v89, v89, v61
    v_mul_f32 v90, v90, v62
    v_mul_f32 v91, v91, v63
    v_mul_f32 v92, v92, v64
    v_mul_f32 v93, v93, v65
    v_mul_f32 v94, v94, v66
    v_mul_f32 v95, v95, v67
    s_waitcnt lgkmcnt(5)
    v_lshlrev_b32 v44, 16, v98
    v_and_b32 v45, 0xffff0000, v98
    v_lshlrev_b32 v46, 16, v99
    v_and_b32 v47, 0xffff0000, v99
    s_waitcnt lgkmcnt(4)
    v_lshlrev_b32 v48, 16, v100
    v_and_b32 v49, 0xffff0000, v100
    v_lshlrev_b32 v50, 16, v101
    v_and_b32 v51, 0xffff0000, v101
    s_waitcnt lgkmcnt(3)
    v_lshlrev_b32 v52, 16, v102
    v_and_b32 v53, 0xffff0000, v102
    v_lshlrev_b32 v54, 16, v103
    v_and_b32 v55, 0xffff0000, v103
    s_waitcnt lgkmcnt(2)
    v_lshlrev_b32 v56, 16, v104
    v_and_b32 v57, 0xffff0000, v104
    v_lshlrev_b32 v58, 16, v105
    v_and_b32 v59, 0xffff0000, v105
    s_waitcnt lgkmcnt(1)
    v_lshlrev_b32 v60, 16, v106
    v_and_b32 v61, 0xffff0000, v106
    v_lshlrev_b32 v62, 16, v107
    v_and_b32 v63, 0xffff0000, v107
    s_waitcnt lgkmcnt(0)
    v_lshlrev_b32 v64, 16, v108
    v_and_b32 v65, 0xffff0000, v108
    v_lshlrev_b32 v66, 16, v109
    v_and_b32 v67, 0xffff0000, v109
    v_fmac_f32 v124, v72, v44
    v_fmac_f32 v124, v73, v45
    v_fmac_f32 v124, v74, v46
    v_fmac_f32 v124, v75, v47
    v_fmac_f32 v124, v76, v48
    v_fmac_f32 v124, v77, v49
    v_fmac_f32 v124, v78, v50
    v_fmac_f32 v124, v79, v51
    v_fmac_f32 v124, v80, v52
    v_fmac_f32 v124, v81, v53
    v_fmac_f32 v124, v82, v54
    v_fmac_f32 v124, v83, v55
    v_fmac_f32 v124, v84, v56
    v_fmac_f32 v124, v85, v57
    v_fmac_f32 v124, v86, v58
    v_fmac_f32 v124, v87, v59
    v_fmac_f32 v124, v88, v60
    v_fmac_f32 v124, v89, v61
    v_fmac_f32 v124, v90, v62
    v_fmac_f32 v124, v91, v63
    v_fmac_f32 v124, v92, v64
    v_fmac_f32 v124, v93, v65
    v_fmac_f32 v124, v94, v66
    v_fmac_f32 v124, v95, v67
    v_mov_b32 v125, v124
    s_nop 1
    v_permlane16_swap_b32 v124, v125
    v_add_f32 v124, v124, v125
    v_mov_b32 v125, v124
    s_nop 1
    v_permlane32_swap_b32 v124, v125
    v_add_f32 v124, v124, v125
    v_lshlrev_b32 v2, 2, v1
    s_and_b32 s69, s68, 3
    s_lshl_b32 s69, s69, 6
    s_add_u32 s69, s69, 156672
    v_add_u32 v2, s69, v2
    v_mov_b32 v3, 1
    s_mov_b64 exec, 0xffff
    ds_write_b32 v2, v124
    s_mov_b64 exec, 0x1
    ds_add_u32 v165, v3 offset:4
    s_mov_b64 exec, -1
    s_waitcnt lgkmcnt(0)
    s_nop 7
L_dnnend:
    ds_read_b32 v68, v39 offset:0
    ds_read_b32 v69, v39 offset:128
    ds_read_b32 v70, v39 offset:256
    ds_read_b32 v71, v39 offset:384
    ds_read_b32 v72, v39 offset:512
    ds_read_b32 v73, v39 offset:640
    ds_read_b32 v74, v39 offset:768
    ds_read_b32 v75, v39 offset:896
    ds_read_b32 v76, v39 offset:1024
    ds_read_b32 v77, v39 offset:1152
    ds_read_b32 v78, v39 offset:1280
    ds_read_b32 v79, v39 offset:1408
    ds_read_b32 v80, v39 offset:1536
    s_waitcnt lgkmcnt(0)
L_x0prep:
    v_lshlrev_b32 v15, 16, v15
    v_and_b32 v2, 47, v1
    v_cmp_eq_u32 vcc, 0, v2
    s_nop 1
    v_cndmask_b32 v15, 0, v15, vcc
    v_and_b32 v16, s77, v68
    v_and_b32 v17, s77, v69
    v_and_b32 v18, s77, v70
    v_and_b32 v19, s77, v71
    v_and_b32 v20, s77, v72
    v_and_b32 v21, s77, v73
    v_and_b32 v22, s77, v74
    v_and_b32 v23, s77, v75
    v_and_b32 v24, s77, v76
    v_and_b32 v25, s77, v77
    v_and_b32 v26, s77, v78
    v_and_b32 v27, s77, v79
    v_and_b32 v28, s77, v80
    v_pk_maximum3_f16 v3, v16, v17, v18
    v_pk_maximum3_f16 v3, v3, v19, v20
    v_pk_maximum3_f16 v3, v3, v21, v22
    v_pk_maximum3_f16 v3, v3, v23, v24
    v_pk_maximum3_f16 v3, v3, v25, v26
    v_pk_maximum3_f16 v3, v3, v27, v28
    v_max_u16_sdwa v3, v3, v3 dst_sel:DWORD dst_unused:UNUSED_PAD src0_sel:WORD_1 src1_sel:WORD_0
    s_nop 0
    v_lshrrev_b32 v3, 7, v3
    v_subrev_u32 v3, 21, v3
    v_max_i32 v3, 0, v3
    v_subrev_u32 v14, 112, v3
    v_mul_u32_u24 v3, 0x800080, v3
    v_pk_sub_u16 v16, v16, v3 clamp
    v_pk_sub_u16 v17, v17, v3 clamp
    v_pk_sub_u16 v18, v18, v3 clamp
    v_pk_sub_u16 v19, v19, v3 clamp
    v_pk_sub_u16 v20, v20, v3 clamp
    v_pk_sub_u16 v21, v21, v3 clamp
    v_pk_sub_u16 v22, v22, v3 clamp
    v_pk_sub_u16 v23, v23, v3 clamp
    v_pk_sub_u16 v24, v24, v3 clamp
    v_pk_sub_u16 v25, v25, v3 clamp
    v_pk_sub_u16 v26, v26, v3 clamp
    v_pk_sub_u16 v27, v27, v3 clamp
    v_pk_sub_u16 v28, v28, v3 clamp
    v_lshlrev_b32 v16, 3, v16
    v_lshlrev_b32 v17, 3, v17
    v_lshlrev_b32 v18, 3, v18
    v_lshlrev_b32 v19, 3, v19
    v_lshlrev_b32 v20, 3, v20
    v_lshlrev_b32 v21, 3, v21
    v_lshlrev_b32 v22, 3, v22
    v_lshlrev_b32 v23, 3, v23
    v_lshlrev_b32 v24, 3, v24
    v_lshlrev_b32 v25, 3, v25
    v_lshlrev_b32 v26, 3, v26
    v_lshlrev_b32 v27, 3, v27
    v_lshlrev_b32 v28, 3, v28
    v_bfi_b32 v16, s78, v68, v16
    v_bfi_b32 v17, s78, v69, v17
    v_bfi_b32 v18, s78, v70, v18
    v_bfi_b32 v19, s78, v71, v19
    v_bfi_b32 v20, s78, v72, v20
    v_bfi_b32 v21, s78, v73, v21
    v_bfi_b32 v22, s78, v74, v22
    v_bfi_b32 v23, s78, v75, v23
    v_bfi_b32 v24, s78, v76, v24
    v_bfi_b32 v25, s78, v77, v25
    v_bfi_b32 v26, s78, v78, v26
    v_bfi_b32 v27, s78, v79, v27
    v_bfi_b32 v28, s78, v80, v28
    v_mov_b32 v29, 0
    v_mov_b32 v4, 0x05040100
    v_mov_b32 v3, 0x07060302
    v_cndmask_b32 v4, v4, v3, s[74:75]
    v_perm_b32 v32, v17, v16, v4
    v_perm_b32 v33, v19, v18, v4
    v_perm_b32 v34, v21, v20, v4
    v_perm_b32 v35, v23, v22, v4
    v_perm_b32 v36, v25, v24, v4
    v_perm_b32 v37, v27, v26, v4
    v_perm_b32 v38, v29, v28, v4
    v_lshlrev_b32 v13, 1, v14
    v_pk_mul_f16 v152, v32, s82
    v_pk_mul_f16 v153, v33, s82
    v_pk_mul_f16 v154, v34, s82
    v_pk_mul_f16 v155, v35, s82
    v_pk_mul_f16 v156, v36, s82
    v_pk_mul_f16 v157, v37, s82
    v_pk_mul_f16 v158, v38, s82
    v_and_b32 v2, 31, v1
    v_cmp_gt_u32 vcc, 28, v2
    s_nop 1
    v_addc_co_u32 v6, vcc, 0, v2, vcc
    v_cmp_eq_u32 s[84:85], 28, v2
    s_nop 1
    v_cndmask_b32 v6, v6, 0, s[84:85]
    v_lshrrev_b32 v3, 5, v1
    v_mad_u32_u24 v6, v3, 26, v6
    v_cmp_gt_u32 vcc, 25, v2
    s_nop 0
    s_or_b64 vcc, vcc, s[84:85]
    v_mov_b32 v7, 0x40000
    v_cndmask_b32 v7, v7, 0, vcc
    s_movk_i32 s69, 0x2b0
    s_movk_i32 s70, 0x170
    v_mad_u32_u24 v159, v6, s69, v7
    v_add_u32 v160, 71552, v159
    v_mad_u32_u24 v161, v6, s70, v7
    v_add_u32 v161, 123968, v161
    v_lshrrev_b32 v3, 5, v1
    v_lshlrev_b32 v3, 6, v3
    v_add_u32 v101, 160768, v3
    v_mov_b32 v71, 0
    ds_read_b32 v166, v165 offset:8
    s_waitcnt lgkmcnt(0)
    v_readfirstlane_b32 s69, v166
    s_nop 0
    s_cmp_ge_u32 s69, 1
    s_cbranch_scc1 L_ok16
    s_mov_b32 s70, 0x100000
L_sp16:
    s_sleep 1
    ds_read_b32 v166, v165 offset:8
    s_sub_u32 s70, s70, 1
    s_cbranch_scc1 L_ok16
    s_waitcnt lgkmcnt(0)
    v_readfirstlane_b32 s69, v166
    s_nop 0
    s_cmp_ge_u32 s69, 1
    s_cbranch_scc0 L_sp16
L_ok16:
    ds_read_b128 v[72:75], v161 offset:0
    ds_read_b128 v[76:79], v161 offset:16
    ds_read_b128 v[80:83], v161 offset:32
    ds_read_b128 v[84:87], v161 offset:48
    ds_read_b128 v[4:7], v161 offset:64
    v_pk_mul_f16 v56, v152, v16 op_sel:[0,0] op_sel_hi:[0,1]
    v_pk_mul_f16 v57, v32, v17 op_sel:[0,0] op_sel_hi:[0,1]
    v_pk_mul_f16 v58, v32, v18 op_sel:[0,0] op_sel_hi:[0,1]
    v_pk_mul_f16 v59, v32, v19 op_sel:[0,0] op_sel_hi:[0,1]
    v_pk_mul_f16 v60, v32, v20 op_sel:[0,0] op_sel_hi:[0,1]
    v_pk_mul_f16 v61, v32, v21 op_sel:[0,0] op_sel_hi:[0,1]
    v_pk_mul_f16 v62, v32, v22 op_sel:[0,0] op_sel_hi:[0,1]
    v_pk_mul_f16 v63, v32, v23 op_sel:[0,0] op_sel_hi:[0,1]
    s_setprio 1
    s_waitcnt lgkmcnt(3)
    v_mfma_f32_32x32x16_f16 v[40:55], v[72:75], v[56:59], 0
    ds_read_b128 v[8:11], v161 offset:80
    v_pk_mul_f16 v64, v32, v24 op_sel:[0,0] op_sel_hi:[0,1]
    v_pk_mul_f16 v65, v32, v25 op_sel:[0,0] op_sel_hi:[0,1]
    v_pk_mul_f16 v66, v32, v26 op_sel:[0,0] op_sel_hi:[0,1]
    v_pk_mul_f16 v67, v32, v27 op_sel:[0,0] op_sel_hi:[0,1]
    v_mfma_f32_32x32x16_f16 v[40:55], v[76:79], v[60:63], v[40:55]
    ds_read_b128 v[72:75], v161 offset:96
    v_pk_mul_f16 v56, v32, v28 op_sel:[0,0] op_sel_hi:[0,1]
    v_pk_mul_f16 v57, v152, v17 op_sel:[1,0] op_sel_hi:[1,1]
    v_pk_mul_f16 v58, v32, v18 op_sel:[1,0] op_sel_hi:[1,1]
    v_pk_mul_f16 v59, v32, v19 op_sel:[1,0] op_sel_hi:[1,1]
    s_waitcnt lgkmcnt(3)
    v_mfma_f32_32x32x16_f16 v[40:55], v[80:83], v[64:67], v[40:55]
    ds_read_b128 v[76:79], v161 offset:112
    v_pk_mul_f16 v60, v32, v20 op_sel:[1,0] op_sel_hi:[1,1]
    v_pk_mul_f16 v61, v32, v21 op_sel:[1,0] op_sel_hi:[1,1]
    v_pk_mul_f16 v62, v32, v22 op_sel:[1,0] op_sel_hi:[1,1]
    v_pk_mul_f16 v63, v32, v23 op_sel:[1,0] op_sel_hi:[1,1]
    s_setprio 2
    v_mfma_f32_32x32x16_f16 v[40:55], v[84:87], v[56:59], v[40:55]
    ds_read_b128 v[80:83], v161 offset:128
    v_pk_mul_f16 v64, v32, v24 op_sel:[1,0] op_sel_hi:[1,1]
    v_pk_mul_f16 v65, v32, v25 op_sel:[1,0] op_sel_hi:[1,1]
    v_pk_mul_f16 v66, v32, v26 op_sel:[1,0] op_sel_hi:[1,1]
    v_pk_mul_f16 v67, v32, v27 op_sel:[1,0] op_sel_hi:[1,1]
    s_waitcnt lgkmcnt(3)
    v_mfma_f32_32x32x16_f16 v[40:55], v[4:7], v[60:63], v[40:55]
    ds_read_b128 v[84:87], v161 offset:144
    v_pk_mul_f16 v56, v32, v28 op_sel:[1,0] op_sel_hi:[1,1]
    v_pk_mul_f16 v57, v153, v18 op_sel:[0,0] op_sel_hi:[0,1]
    v_pk_mul_f16 v58, v33, v19 op_sel:[0,0] op_sel_hi:[0,1]
    v_pk_mul_f16 v59, v33, v20 op_sel:[0,0] op_sel_hi:[0,1]
    v_mfma_f32_32x32x16_f16 v[40:55], v[8:11], v[64:67], v[40:55]
    ds_read_b128 v[4:7], v161 offset:160
    v_pk_mul_f16 v60, v33, v21 op_sel:[0,0] op_sel_hi:[0,1]
    v_pk_mul_f16 v61, v33, v22 op_sel:[0,0] op_sel_hi:[0,1]
    v_pk_mul_f16 v62, v33, v23 op_sel:[0,0] op_sel_hi:[0,1]
    v_pk_mul_f16 v63, v33, v24 op_sel:[0,0] op_sel_hi:[0,1]
    s_waitcnt lgkmcnt(3)
    v_mfma_f32_32x32x16_f16 v[40:55], v[72:75], v[56:59], v[40:55]
    ds_read_b128 v[8:11], v161 offset:176
    v_pk_mul_f16 v64, v33, v25 op_sel:[0,0] op_sel_hi:[0,1]
    v_pk_mul_f16 v65, v33, v26 op_sel:[0,0] op_sel_hi:[0,1]
    v_pk_mul_f16 v66, v33, v27 op_sel:[0,0] op_sel_hi:[0,1]
    v_pk_mul_f16 v67, v33, v28 op_sel:[0,0] op_sel_hi:[0,1]
    v_mfma_f32_32x32x16_f16 v[40:55], v[76:79], v[60:63], v[40:55]
    ds_read_b128 v[72:75], v161 offset:192
    v_pk_mul_f16 v56, v153, v19 op_sel:[1,0] op_sel_hi:[1,1]
    v_pk_mul_f16 v57, v33, v20 op_sel:[1,0] op_sel_hi:[1,1]
    v_pk_mul_f16 v58, v33, v21 op_sel:[1,0] op_sel_hi:[1,1]
    v_pk_mul_f16 v59, v33, v22 op_sel:[1,0] op_sel_hi:[1,1]
    s_waitcnt lgkmcnt(3)
    v_mfma_f32_32x32x16_f16 v[40:55], v[80:83], v[64:67], v[40:55]
    ds_read_b128 v[76:79], v161 offset:208
    v_pk_mul_f16 v60, v33, v23 op_sel:[1,0] op_sel_hi:[1,1]
    v_pk_mul_f16 v61, v33, v24 op_sel:[1,0] op_sel_hi:[1,1]
    v_pk_mul_f16 v62, v33, v25 op_sel:[1,0] op_sel_hi:[1,1]
    v_pk_mul_f16 v63, v33, v26 op_sel:[1,0] op_sel_hi:[1,1]
    v_mfma_f32_32x32x16_f16 v[40:55], v[84:87], v[56:59], v[40:55]
    ds_read_b128 v[80:83], v161 offset:224
    v_pk_mul_f16 v64, v33, v27 op_sel:[1,0] op_sel_hi:[1,1]
    v_pk_mul_f16 v65, v33, v28 op_sel:[1,0] op_sel_hi:[1,1]
    v_pk_mul_f16 v66, v154, v20 op_sel:[0,0] op_sel_hi:[0,1]
    v_pk_mul_f16 v67, v34, v21 op_sel:[0,0] op_sel_hi:[0,1]
    s_waitcnt lgkmcnt(3)
    v_mfma_f32_32x32x16_f16 v[40:55], v[4:7], v[60:63], v[40:55]
    ds_read_b128 v[84:87], v161 offset:240
    v_pk_mul_f16 v56, v34, v22 op_sel:[0,0] op_sel_hi:[0,1]
    v_pk_mul_f16 v57, v34, v23 op_sel:[0,0] op_sel_hi:[0,1]
    v_pk_mul_f16 v58, v34, v24 op_sel:[0,0] op_sel_hi:[0,1]
    v_pk_mul_f16 v59, v34, v25 op_sel:[0,0] op_sel_hi:[0,1]
    v_mfma_f32_32x32x16_f16 v[40:55], v[8:11], v[64:67], v[40:55]
    ds_read_b128 v[4:7], v161 offset:256
    v_pk_mul_f16 v60, v34, v26 op_sel:[0,0] op_sel_hi:[0,1]
    v_pk_mul_f16 v61, v34, v27 op_sel:[0,0] op_sel_hi:[0,1]
    v_pk_mul_f16 v62, v34, v28 op_sel:[0,0] op_sel_hi:[0,1]
    v_pk_mul_f16 v63, v154, v21 op_sel:[1,0] op_sel_hi:[1,1]
    s_waitcnt lgkmcnt(3)
    v_mfma_f32_32x32x16_f16 v[40:55], v[72:75], v[56:59], v[40:55]
    ds_read_b128 v[8:11], v161 offset:272
    v_pk_mul_f16 v64, v34, v22 op_sel:[1,0] op_sel_hi:[1,1]
    v_pk_mul_f16 v65, v34, v23 op_sel:[1,0] op_sel_hi:[1,1]
    v_pk_mul_f16 v66, v34, v24 op_sel:[1,0] op_sel_hi:[1,1]
    v_pk_mul_f16 v67, v34, v25 op_sel:[1,0] op_sel_hi:[1,1]
    v_mfma_f32_32x32x16_f16 v[40:55], v[76:79], v[60:63], v[40:55]
    ds_read_b128 v[72:75], v161 offset:288
    v_pk_mul_f16 v56, v34, v26 op_sel:[1,0] op_sel_hi:[1,1]
    v_pk_mul_f16 v57, v34, v27 op_sel:[1,0] op_sel_hi:[1,1]
    v_pk_mul_f16 v58, v34, v28 op_sel:[1,0] op_sel_hi:[1,1]
    v_pk_mul_f16 v59, v155, v22 op_sel:[0,0] op_sel_hi:[0,1]
    s_waitcnt lgkmcnt(3)
    v_mfma_f32_32x32x16_f16 v[40:55], v[80:83], v[64:67], v[40:55]
    ds_read_b128 v[76:79], v161 offset:304
    v_pk_mul_f16 v60, v35, v23 op_sel:[0,0] op_sel_hi:[0,1]
    v_pk_mul_f16 v61, v35, v24 op_sel:[0,0] op_sel_hi:[0,1]
    v_pk_mul_f16 v62, v35, v25 op_sel:[0,0] op_sel_hi:[0,1]
    v_pk_mul_f16 v63, v35, v26 op_sel:[0,0] op_sel_hi:[0,1]
    ds_read_b128 v[88:91], v101 offset:640
    ds_read_b128 v[92:95], v101 offset:656
    ds_read_b128 v[96:99], v101 offset:672
    ds_read_b32 v100, v101 offset:688
    ds_read_b128 v[102:105], v101 offset:0
    ds_read_b128 v[106:109], v101 offset:16
    ds_read_b128 v[110:113], v101 offset:32
    ds_read_b32 v114, v101 offset:48
    v_mfma_f32_32x32x16_f16 v[40:55], v[84:87], v[56:59], v[40:55]
    ds_read_b128 v[80:83], v161 offset:320
    v_pk_mul_f16 v64, v35, v27 op_sel:[0,0] op_sel_hi:[0,1]
    v_pk_mul_f16 v65, v35, v28 op_sel:[0,0] op_sel_hi:[0,1]
    v_pk_mul_f16 v66, v155, v23 op_sel:[1,0] op_sel_hi:[1,1]
    v_pk_mul_f16 v67, v35, v24 op_sel:[1,0] op_sel_hi:[1,1]
    s_waitcnt lgkmcnt(11)
    v_mfma_f32_32x32x16_f16 v[40:55], v[4:7], v[60:63], v[40:55]
    ds_read_b128 v[84:87], v161 offset:336
    v_pk_mul_f16 v56, v35, v25 op_sel:[1,0] op_sel_hi:[1,1]
    v_pk_mul_f16 v57, v35, v26 op_sel:[1,0] op_sel_hi:[1,1]
    v_pk_mul_f16 v58, v35, v27 op_sel:[1,0] op_sel_hi:[1,1]
    v_pk_mul_f16 v59, v35, v28 op_sel:[1,0] op_sel_hi:[1,1]
    v_mfma_f32_32x32x16_f16 v[40:55], v[8:11], v[64:67], v[40:55]
    ds_read_b128 v[4:7], v161 offset:352
    v_pk_mul_f16 v60, v156, v24 op_sel:[0,0] op_sel_hi:[0,1]
    v_pk_mul_f16 v61, v36, v25 op_sel:[0,0] op_sel_hi:[0,1]
    v_pk_mul_f16 v62, v36, v26 op_sel:[0,0] op_sel_hi:[0,1]
    v_pk_mul_f16 v63, v36, v27 op_sel:[0,0] op_sel_hi:[0,1]
    s_waitcnt lgkmcnt(11)
    v_mfma_f32_32x32x16_f16 v[40:55], v[72:75], v[56:59], v[40:55]
    v_pk_mul_f16 v64, v36, v28 op_sel:[0,0] op_sel_hi:[0,1]
    v_pk_mul_f16 v65, v156, v25 op_sel:[1,0] op_sel_hi:[1,1]
    v_pk_mul_f16 v66, v36, v26 op_sel:[1,0] op_sel_hi:[1,1]
    v_pk_mul_f16 v67, v36, v27 op_sel:[1,0] op_sel_hi:[1,1]
    v_mfma_f32_32x32x16_f16 v[40:55], v[76:79], v[60:63], v[40:55]
    v_pk_mul_f16 v56, v36, v28 op_sel:[1,0] op_sel_hi:[1,1]
    v_pk_mul_f16 v57, v157, v26 op_sel:[0,0] op_sel_hi:[0,1]
    v_pk_mul_f16 v58, v37, v27 op_sel:[0,0] op_sel_hi:[0,1]
    v_pk_mul_f16 v59, v37, v28 op_sel:[0,0] op_sel_hi:[0,1]
    s_waitcnt lgkmcnt(1)
    v_mfma_f32_32x32x16_f16 v[40:55], v[80:83], v[64:67], v[40:55]
    v_pk_mul_f16 v68, v157, v27 op_sel:[1,0] op_sel_hi:[1,1]
    v_pk_mul_f16 v69, v37, v28 op_sel:[1,0] op_sel_hi:[1,1]
    v_pk_mul_f16 v70, v158, v28 op_sel:[0,0] op_sel_hi:[0,1]
    v_mfma_f32_32x32x16_f16 v[40:55], v[84:87], v[56:59], v[40:55]
    s_waitcnt lgkmcnt(0)
    v_mfma_f32_32x32x16_f16 v[40:55], v[4:7], v[68:71], v[40:55]
    v_mov_b32 v2, 4
    ds_write_b32 v167, v2
    s_setprio 0
    s_nop 8
    v_ldexp_f32 v40, v40, v102
    v_ldexp_f32 v41, v41, v103
    v_ldexp_f32 v42, v42, v104
    v_ldexp_f32 v43, v43, v105
    v_ldexp_f32 v44, v44, v106
    v_ldexp_f32 v45, v45, v107
    v_ldexp_f32 v46, v46, v108
    v_ldexp_f32 v47, v47, v109
    v_ldexp_f32 v48, v48, v110
    v_ldexp_f32 v49, v49, v111
    v_ldexp_f32 v50, v50, v112
    v_ldexp_f32 v51, v51, v113
    v_ldexp_f32 v52, v52, v114
    v_max3_f32 v65, |v40|, |v41|, |v42|
    v_max3_f32 v65, |v43|, |v44|, v65
    v_max3_f32 v65, |v45|, |v46|, v65
    v_max3_f32 v65, |v47|, |v48|, v65
    v_max3_f32 v65, |v49|, |v50|, v65
    v_max3_f32 v65, |v51|, |v52|, v65
    v_mov_b32 v66, v65
    v_mul_f32 v64, v40, v88
    v_fmac_f32 v64, v41, v89
    v_permlane32_swap_b32 v65, v66
    v_fmac_f32 v64, v42, v90
    v_max_f32 v65, v65, v66
    v_frexp_exp_i32_f32 v65, v65
    v_sub_u32 v30, 8, v65
    v_fmac_f32 v64, v43, v91
    v_fmac_f32 v64, v44, v92
    v_fmac_f32 v64, v45, v93
    v_fmac_f32 v64, v46, v94
    v_fmac_f32 v64, v47, v95
    v_fmac_f32 v64, v48, v96
    v_fmac_f32 v64, v49, v97
    v_fmac_f32 v64, v50, v98
    v_fmac_f32 v64, v51, v99
    v_fmac_f32 v64, v52, v100
    v_ldexp_f32 v40, v40, v30
    v_ldexp_f32 v41, v41, v30
    v_ldexp_f32 v42, v42, v30
    v_ldexp_f32 v43, v43, v30
    v_ldexp_f32 v44, v44, v30
    v_ldexp_f32 v45, v45, v30
    v_ldexp_f32 v46, v46, v30
    v_ldexp_f32 v47, v47, v30
    v_ldexp_f32 v48, v48, v30
    v_ldexp_f32 v49, v49, v30
    v_ldexp_f32 v50, v50, v30
    v_ldexp_f32 v51, v51, v30
    v_ldexp_f32 v52, v52, v30
    v_cvt_pk_f16_f32 v32, v40, v41
    v_cvt_pk_f16_f32 v33, v42, v43
    v_cvt_pk_f16_f32 v34, v44, v45
    v_cvt_pk_f16_f32 v35, v46, v47
    v_cvt_pk_f16_f32 v36, v48, v49
    v_cvt_pk_f16_f32 v37, v50, v51
    v_cvt_pk_f16_f32 v38, v52, v52
    v_ldexp_f32 v64, v64, v13
    v_add_f32 v15, v15, v64
    v_sub_u32 v13, v13, v30
    v_add_u32 v13, v13, v14
    v_mov_b32 v69, 0
    v_mov_b32 v70, 0
    ds_read_b32 v166, v165 offset:8
    s_waitcnt lgkmcnt(0)
    v_readfirstlane_b32 s69, v166
    s_nop 0
    s_cmp_ge_u32 s69, 2
    s_cbranch_scc1 L_ok17
    s_mov_b32 s70, 0x100000
L_sp17:
    s_sleep 1
    ds_read_b32 v166, v165 offset:8
    s_sub_u32 s70, s70, 1
    s_cbranch_scc1 L_ok17
    s_waitcnt lgkmcnt(0)
    v_readfirstlane_b32 s69, v166
    s_nop 0
    s_cmp_ge_u32 s69, 2
    s_cbranch_scc0 L_sp17
L_ok17:
    ds_read_b128 v[72:75], v159 offset:0
    ds_read_b128 v[76:79], v159 offset:16
    ds_read_b128 v[80:83], v159 offset:32
    ds_read_b128 v[84:87], v159 offset:48
    ds_read_b128 v[4:7], v159 offset:64
    v_pk_mul_f16 v56, v32, v16 op_sel:[0,0] op_sel_hi:[0,1]
    v_pk_mul_f16 v57, v32, v17 op_sel:[0,0] op_sel_hi:[0,1]
    v_pk_mul_f16 v58, v32, v18 op_sel:[0,0] op_sel_hi:[0,1]
    v_pk_mul_f16 v59, v32, v19 op_sel:[0,0] op_sel_hi:[0,1]
    v_pk_mul_f16 v60, v32, v20 op_sel:[0,0] op_sel_hi:[0,1]
    v_pk_mul_f16 v61, v32, v21 op_sel:[0,0] op_sel_hi:[0,1]
    v_pk_mul_f16 v62, v32, v22 op_sel:[0,0] op_sel_hi:[0,1]
    v_pk_mul_f16 v63, v32, v23 op_sel:[0,0] op_sel_hi:[0,1]
    s_setprio 1
    s_waitcnt lgkmcnt(3)
    v_mfma_f32_32x32x16_f16 v[40:55], v[72:75], v[56:59], 0
    ds_read_b128 v[8:11], v159 offset:80
    v_pk_mul_f16 v64, v32, v24 op_sel:[0,0] op_sel_hi:[0,1]
    v_pk_mul_f16 v65, v32, v25 op_sel:[0,0] op_sel_hi:[0,1]
    v_pk_mul_f16 v66, v32, v26 op_sel:[0,0] op_sel_hi:[0,1]
    v_pk_mul_f16 v67, v32, v27 op_sel:[0,0] op_sel_hi:[0,1]
    v_mfma_f32_32x32x16_f16 v[40:55], v[76:79], v[60:63], v[40:55]
    ds_read_b128 v[72:75], v159 offset:96
    v_pk_mul_f16 v56, v32, v28 op_sel:[0,0] op_sel_hi:[0,1]
    v_pk_mul_f16 v57, v32, v16 op_sel:[1,0] op_sel_hi:[1,1]
    v_pk_mul_f16 v58, v32, v17 op_sel:[1,0] op_sel_hi:[1,1]
    v_pk_mul_f16 v59, v32, v18 op_sel:[1,0] op_sel_hi:[1,1]
    s_waitcnt lgkmcnt(3)
    v_mfma_f32_32x32x16_f16 v[40:55], v[80:83], v[64:67], v[40:55]
    ds_read_b128 v[76:79], v159 offset:112
    v_pk_mul_f16 v60, v32, v19 op_sel:[1,0] op_sel_hi:[1,1]
    v_pk_mul_f16 v61, v32, v20 op_sel:[1,0] op_sel_hi:[1,1]
    v_pk_mul_f16 v62, v32, v21 op_sel:[1,0] op_sel_hi:[1,1]
    v_pk_mul_f16 v63, v32, v22 op_sel:[1,0] op_sel_hi:[1,1]
    s_setprio 2
    v_mfma_f32_32x32x16_f16 v[40:55], v[84:87], v[56:59], v[40:55]
    ds_read_b128 v[80:83], v159 offset:128
    v_pk_mul_f16 v64, v32, v23 op_sel:[1,0] op_sel_hi:[1,1]
    v_pk_mul_f16 v65, v32, v24 op_sel:[1,0] op_sel_hi:[1,1]
    v_pk_mul_f16 v66, v32, v25 op_sel:[1,0] op_sel_hi:[1,1]
    v_pk_mul_f16 v67, v32, v26 op_sel:[1,0] op_sel_hi:[1,1]
    s_waitcnt lgkmcnt(3)
    v_mfma_f32_32x32x16_f16 v[40:55], v[4:7], v[60:63], v[40:55]
    ds_read_b128 v[84:87], v159 offset:144
    v_pk_mul_f16 v56, v32, v27 op_sel:[1,0] op_sel_hi:[1,1]
    v_pk_mul_f16 v57, v32, v28 op_sel:[1,0] op_sel_hi:[1,1]
    v_pk_mul_f16 v58, v33, v16 op_sel:[0,0] op_sel_hi:[0,1]
    v_pk_mul_f16 v59, v33, v17 op_sel:[0,0] op_sel_hi:[0,1]
    v_mfma_f32_32x32x16_f16 v[40:55], v[8:11], v[64:67], v[40:55]
    ds_read_b128 v[4:7], v159 offset:160
    v_pk_mul_f16 v60, v33, v18 op_sel:[0,0] op_sel_hi:[0,1]
    v_pk_mul_f16 v61, v33, v19 op_sel:[0,0] op_sel_hi:[0,1]
    v_pk_mul_f16 v62, v33, v20 op_sel:[0,0] op_sel_hi:[0,1]
    v_pk_mul_f16 v63, v33, v21 op_sel:[0,0] op_sel_hi:[0,1]
    s_waitcnt lgkmcnt(3)
    v_mfma_f32_32x32x16_f16 v[40:55], v[72:75], v[56:59], v[40:55]
    ds_read_b128 v[8:11], v159 offset:176
    v_pk_mul_f16 v64, v33, v22 op_sel:[0,0] op_sel_hi:[0,1]
    v_pk_mul_f16 v65, v33, v23 op_sel:[0,0] op_sel_hi:[0,1]
    v_pk_mul_f16 v66, v33, v24 op_sel:[0,0] op_sel_hi:[0,1]
    v_pk_mul_f16 v67, v33, v25 op_sel:[0,0] op_sel_hi:[0,1]
    v_mfma_f32_32x32x16_f16 v[40:55], v[76:79], v[60:63], v[40:55]
    ds_read_b128 v[72:75], v159 offset:192
    v_pk_mul_f16 v56, v33, v26 op_sel:[0,0] op_sel_hi:[0,1]
    v_pk_mul_f16 v57, v33, v27 op_sel:[0,0] op_sel_hi:[0,1]
    v_pk_mul_f16 v58, v33, v28 op_sel:[0,0] op_sel_hi:[0,1]
    v_pk_mul_f16 v59, v33, v16 op_sel:[1,0] op_sel_hi:[1,1]
    s_waitcnt lgkmcnt(3)
    v_mfma_f32_32x32x16_f16 v[40:55], v[80:83], v[64:67], v[40:55]
    ds_read_b128 v[76:79], v159 offset:208
    v_pk_mul_f16 v60, v33, v17 op_sel:[1,0] op_sel_hi:[1,1]
    v_pk_mul_f16 v61, v33, v18 op_sel:[1,0] op_sel_hi:[1,1]
    v_pk_mul_f16 v62, v33, v19 op_sel:[1,0] op_sel_hi:[1,1]
    v_pk_mul_f16 v63, v33, v20 op_sel:[1,0] op_sel_hi:[1,1]
    v_mfma_f32_32x32x16_f16 v[40:55], v[84:87], v[56:59], v[40:55]
    ds_read_b128 v[80:83], v159 offset:224
    v_pk_mul_f16 v64, v33, v21 op_sel:[1,0] op_sel_hi:[1,1]
    v_pk_mul_f16 v65, v33, v22 op_sel:[1,0] op_sel_hi:[1,1]
    v_pk_mul_f16 v66, v33, v23 op_sel:[1,0] op_sel_hi:[1,1]
    v_pk_mul_f16 v67, v33, v24 op_sel:[1,0] op_sel_hi:[1,1]
    s_waitcnt lgkmcnt(3)
    v_mfma_f32_32x32x16_f16 v[40:55], v[4:7], v[60:63], v[40:55]
    ds_read_b128 v[84:87], v159 offset:240
    v_pk_mul_f16 v56, v33, v25 op_sel:[1,0] op_sel_hi:[1,1]
    v_pk_mul_f16 v57, v33, v26 op_sel:[1,0] op_sel_hi:[1,1]
    v_pk_mul_f16 v58, v33, v27 op_sel:[1,0] op_sel_hi:[1,1]
    v_pk_mul_f16 v59, v33, v28 op_sel:[1,0] op_sel_hi:[1,1]
    v_mfma_f32_32x32x16_f16 v[40:55], v[8:11], v[64:67], v[40:55]
    ds_read_b128 v[4:7], v159 offset:256
    v_pk_mul_f16 v60, v34, v16 op_sel:[0,0] op_sel_hi:[0,1]
    v_pk_mul_f16 v61, v34, v17 op_sel:[0,0] op_sel_hi:[0,1]
    v_pk_mul_f16 v62, v34, v18 op_sel:[0,0] op_sel_hi:[0,1]
    v_pk_mul_f16 v63, v34, v19 op_sel:[0,0] op_sel_hi:[0,1]
    s_waitcnt lgkmcnt(3)
    v_mfma_f32_32x32x16_f16 v[40:55], v[72:75], v[56:59], v[40:55]
    ds_read_b128 v[8:11], v159 offset:272
    v_pk_mul_f16 v64, v34, v20 op_sel:[0,0] op_sel_hi:[0,1]
    v_pk_mul_f16 v65, v34, v21 op_sel:[0,0] op_sel_hi:[0,1]
    v_pk_mul_f16 v66, v34, v22 op_sel:[0,0] op_sel_hi:[0,1]
    v_pk_mul_f16 v67, v34, v23 op_sel:[0,0] op_sel_hi:[0,1]
    v_mfma_f32_32x32x16_f16 v[40:55], v[76:79], v[60:63], v[40:55]
    ds_read_b128 v[72:75], v159 offset:288
    v_pk_mul_f16 v56, v34, v24 op_sel:[0,0] op_sel_hi:[0,1]
    v_pk_mul_f16 v57, v34, v25 op_sel:[0,0] op_sel_hi:[0,1]
    v_pk_mul_f16 v58, v34, v26 op_sel:[0,0] op_sel_hi:[0,1]
    v_pk_mul_f16 v59, v34, v27 op_sel:[0,0] op_sel_hi:[0,1]
    s_waitcnt lgkmcnt(3)
    v_mfma_f32_32x32x16_f16 v[40:55], v[80:83], v[64:67], v[40:55]
    ds_read_b128 v[76:79], v159 offset:304
    v_pk_mul_f16 v60, v34, v28 op_sel:[0,0] op_sel_hi:[0,1]
    v_pk_mul_f16 v61, v34, v16 op_sel:[1,0] op_sel_hi:[1,1]
    v_pk_mul_f16 v62, v34, v17 op_sel:[1,0] op_sel_hi:[1,1]
    v_pk_mul_f16 v63, v34, v18 op_sel:[1,0] op_sel_hi:[1,1]
    v_mfma_f32_32x32x16_f16 v[40:55], v[84:87], v[56:59], v[40:55]
    ds_read_b128 v[80:83], v159 offset:320
    v_pk_mul_f16 v64, v34, v19 op_sel:[1,0] op_sel_hi:[1,1]
    v_pk_mul_f16 v65, v34, v20 op_sel:[1,0] op_sel_hi:[1,1]
    v_pk_mul_f16 v66, v34, v21 op_sel:[1,0] op_sel_hi:[1,1]
    v_pk_mul_f16 v67, v34, v22 op_sel:[1,0] op_sel_hi:[1,1]
    s_waitcnt lgkmcnt(3)
    v_mfma_f32_32x32x16_f16 v[40:55], v[4:7], v[60:63], v[40:55]
    ds_read_b128 v[84:87], v159 offset:336
    v_pk_mul_f16 v56, v34, v23 op_sel:[1,0] op_sel_hi:[1,1]
    v_pk_mul_f16 v57, v34, v24 op_sel:[1,0] op_sel_hi:[1,1]
    v_pk_mul_f16 v58, v34, v25 op_sel:[1,0] op_sel_hi:[1,1]
    v_pk_mul_f16 v59, v34, v26 op_sel:[1,0] op_sel_hi:[1,1]
    v_mfma_f32_32x32x16_f16 v[40:55], v[8:11], v[64:67], v[40:55]
    ds_read_b128 v[4:7], v159 offset:352
    v_pk_mul_f16 v60, v34, v27 op_sel:[1,0] op_sel_hi:[1,1]
    v_pk_mul_f16 v61, v34, v28 op_sel:[1,0] op_sel_hi:[1,1]
    v_pk_mul_f16 v62, v35, v16 op_sel:[0,0] op_sel_hi:[0,1]
    v_pk_mul_f16 v63, v35, v17 op_sel:[0,0] op_sel_hi:[0,1]
    s_waitcnt lgkmcnt(3)
    v_mfma_f32_32x32x16_f16 v[40:55], v[72:75], v[56:59], v[40:55]
    ds_read_b128 v[8:11], v159 offset:368
    v_pk_mul_f16 v64, v35, v18 op_sel:[0,0] op_sel_hi:[0,1]
    v_pk_mul_f16 v65, v35, v19 op_sel:[0,0] op_sel_hi:[0,1]
    v_pk_mul_f16 v66, v35, v20 op_sel:[0,0] op_sel_hi:[0,1]
    v_pk_mul_f16 v67, v35, v21 op_sel:[0,0] op_sel_hi:[0,1]
    v_mfma_f32_32x32x16_f16 v[40:55], v[76:79], v[60:63], v[40:55]
    ds_read_b128 v[72:75], v159 offset:384
    v_pk_mul_f16 v56, v35, v22 op_sel:[0,0] op_sel_hi:[0,1]
    v_pk_mul_f16 v57, v35, v23 op_sel:[0,0] op_sel_hi:[0,1]
    v_pk_mul_f16 v58, v35, v24 op_sel:[0,0] op_sel_hi:[0,1]
    v_pk_mul_f16 v59, v35, v25 op_sel:[0,0] op_sel_hi:[0,1]
    s_waitcnt lgkmcnt(3)
    v_mfma_f32_32x32x16_f16 v[40:55], v[80:83], v[64:67], v[40:55]
    ds_read_b128 v[76:79], v159 offset:400
    v_pk_mul_f16 v60, v35, v26 op_sel:[0,0] op_sel_hi:[0,1]
    v_pk_mul_f16 v61, v35, v27 op_sel:[0,0] op_sel_hi:[0,1]
    v_pk_mul_f16 v62, v35, v28 op_sel:[0,0] op_sel_hi:[0,1]
    v_pk_mul_f16 v63, v35, v16 op_sel:[1,0] op_sel_hi:[1,1]
    v_mfma_f32_32x32x16_f16 v[40:55], v[84:87], v[56:59], v[40:55]
    ds_read_b128 v[80:83], v159 offset:416
    v_pk_mul_f16 v64, v35, v17 op_sel:[1,0] op_sel_hi:[1,1]
    v_pk_mul_f16 v65, v35, v18 op_sel:[1,0] op_sel_hi:[1,1]
    v_pk_mul_f16 v66, v35, v19 op_sel:[1,0] op_sel_hi:[1,1]
    v_pk_mul_f16 v67, v35, v20 op_sel:[1,0] op_sel_hi:[1,1]
    s_waitcnt lgkmcnt(3)
    v_mfma_f32_32x32x16_f16 v[40:55], v[4:7], v[60:63], v[40:55]
    ds_read_b128 v[84:87], v159 offset:432
    v_pk_mul_f16 v56, v35, v21 op_sel:[1,0] op_sel_hi:[1,1]
    v_pk_mul_f16 v57, v35, v22 op_sel:[1,0] op_sel_hi:[1,1]
    v_pk_mul_f16 v58, v35, v23 op_sel:[1,0] op_sel_hi:[1,1]
    v_pk_mul_f16 v59, v35, v24 op_sel:[1,0] op_sel_hi:[1,1]
    v_mfma_f32_32x32x16_f16 v[40:55], v[8:11], v[64:67], v[40:55]
    ds_read_b128 v[4:7], v159 offset:448
    v_pk_mul_f16 v60, v35, v25 op_sel:[1,0] op_sel_hi:[1,1]
    v_pk_mul_f16 v61, v35, v26 op_sel:[1,0] op_sel_hi:[1,1]
    v_pk_mul_f16 v62, v35, v27 op_sel:[1,0] op_sel_hi:[1,1]
    v_pk_mul_f16 v63, v35, v28 op_sel:[1,0] op_sel_hi:[1,1]
    s_waitcnt lgkmcnt(3)
    v_mfma_f32_32x32x16_f16 v[40:55], v[72:75], v[56:59], v[40:55]
    ds_read_b128 v[8:11], v159 offset:464
    v_pk_mul_f16 v64, v36, v16 op_sel:[0,0] op_sel_hi:[0,1]
    v_pk_mul_f16 v65, v36, v17 op_sel:[0,0] op_sel_hi:[0,1]
    v_pk_mul_f16 v66, v36, v18 op_sel:[0,0] op_sel_hi:[0,1]
    v_pk_mul_f16 v67, v36, v19 op_sel:[0,0] op_sel_hi:[0,1]
    v_mfma_f32_32x32x16_f16 v[40:55], v[76:79], v[60:63], v[40:55]
    ds_read_b128 v[72:75], v159 offset:480
    v_pk_mul_f16 v56, v36, v20 op_sel:[0,0] op_sel_hi:[0,1]
    v_pk_mul_f16 v57, v36, v21 op_sel:[0,0] op_sel_hi:[0,1]
    v_pk_mul_f16 v58, v36, v22 op_sel:[0,0] op_sel_hi:[0,1]
    v_pk_mul_f16 v59, v36, v23 op_sel:[0,0] op_sel_hi:[0,1]
    s_waitcnt lgkmcnt(3)
    v_mfma_f32_32x32x16_f16 v[40:55], v[80:83], v[64:67], v[40:55]
    ds_read_b128 v[76:79], v159 offset:496
    v_pk_mul_f16 v60, v36, v24 op_sel:[0,0] op_sel_hi:[0,1]
    v_pk_mul_f16 v61, v36, v25 op_sel:[0,0] op_sel_hi:[0,1]
    v_pk_mul_f16 v62, v36, v26 op_sel:[0,0] op_sel_hi:[0,1]
    v_pk_mul_f16 v63, v36, v27 op_sel:[0,0] op_sel_hi:[0,1]
    v_mfma_f32_32x32x16_f16 v[40:55], v[84:87], v[56:59], v[40:55]
    ds_read_b128 v[80:83], v159 offset:512
    v_pk_mul_f16 v64, v36, v28 op_sel:[0,0] op_sel_hi:[0,1]
    v_pk_mul_f16 v65, v36, v16 op_sel:[1,0] op_sel_hi:[1,1]
    v_pk_mul_f16 v66, v36, v17 op_sel:[1,0] op_sel_hi:[1,1]
    v_pk_mul_f16 v67, v36, v18 op_sel:[1,0] op_sel_hi:[1,1]
    s_waitcnt lgkmcnt(3)
    v_mfma_f32_32x32x16_f16 v[40:55], v[4:7], v[60:63], v[40:55]
    ds_read_b128 v[84:87], v159 offset:528
    v_pk_mul_f16 v56, v36, v19 op_sel:[1,0] op_sel_hi:[1,1]
    v_pk_mul_f16 v57, v36, v20 op_sel:[1,0] op_sel_hi:[1,1]
    v_pk_mul_f16 v58, v36, v21 op_sel:[1,0] op_sel_hi:[1,1]
    v_pk_mul_f16 v59, v36, v22 op_sel:[1,0] op_sel_hi:[1,1]
    v_mfma_f32_32x32x16_f16 v[40:55], v[8:11], v[64:67], v[40:55]
    ds_read_b128 v[4:7], v159 offset:544
    v_pk_mul_f16 v60, v36, v23 op_sel:[1,0] op_sel_hi:[1,1]
    v_pk_mul_f16 v61, v36, v24 op_sel:[1,0] op_sel_hi:[1,1]
    v_pk_mul_f16 v62, v36, v25 op_sel:[1,0] op_sel_hi:[1,1]
    v_pk_mul_f16 v63, v36, v26 op_sel:[1,0] op_sel_hi:[1,1]
    s_waitcnt lgkmcnt(3)
    v_mfma_f32_32x32x16_f16 v[40:55], v[72:75], v[56:59], v[40:55]
    ds_read_b128 v[8:11], v159 offset:560
    v_pk_mul_f16 v64, v36, v27 op_sel:[1,0] op_sel_hi:[1,1]
    v_pk_mul_f16 v65, v36, v28 op_sel:[1,0] op_sel_hi:[1,1]
    v_pk_mul_f16 v66, v37, v16 op_sel:[0,0] op_sel_hi:[0,1]
    v_pk_mul_f16 v67, v37, v17 op_sel:[0,0] op_sel_hi:[0,1]
    v_mfma_f32_32x32x16_f16 v[40:55], v[76:79], v[60:63], v[40:55]
    ds_read_b128 v[72:75], v159 offset:576
    v_pk_mul_f16 v56, v37, v18 op_sel:[0,0] op_sel_hi:[0,1]
    v_pk_mul_f16 v57, v37, v19 op_sel:[0,0] op_sel_hi:[0,1]
    v_pk_mul_f16 v58, v37, v20 op_sel:[0,0] op_sel_hi:[0,1]
    v_pk_mul_f16 v59, v37, v21 op_sel:[0,0] op_sel_hi:[0,1]
    s_waitcnt lgkmcnt(3)
    v_mfma_f32_32x32x16_f16 v[40:55], v[80:83], v[64:67], v[40:55]
    ds_read_b128 v[76:79], v159 offset:592
    v_pk_mul_f16 v60, v37, v22 op_sel:[0,0] op_sel_hi:[0,1]
    v_pk_mul_f16 v61, v37, v23 op_sel:[0,0] op_sel_hi:[0,1]
    v_pk_mul_f16 v62, v37, v24 op_sel:[0,0] op_sel_hi:[0,1]
    v_pk_mul_f16 v63, v37, v25 op_sel:[0,0] op_sel_hi:[0,1]
    v_mfma_f32_32x32x16_f16 v[40:55], v[84:87], v[56:59], v[40:55]
    ds_read_b128 v[80:83], v159 offset:608
    v_pk_mul_f16 v64, v37, v26 op_sel:[0,0] op_sel_hi:[0,1]
    v_pk_mul_f16 v65, v37, v27 op_sel:[0,0] op_sel_hi:[0,1]
    v_pk_mul_f16 v66, v37, v28 op_sel:[0,0] op_sel_hi:[0,1]
    v_pk_mul_f16 v67, v37, v16 op_sel:[1,0] op_sel_hi:[1,1]
    s_waitcnt lgkmcnt(3)
    v_mfma_f32_32x32x16_f16 v[40:55], v[4:7], v[60:63], v[40:55]
    ds_read_b128 v[84:87], v159 offset:624
    v_pk_mul_f16 v56, v37, v17 op_sel:[1,0] op_sel_hi:[1,1]
    v_pk_mul_f16 v57, v37, v18 op_sel:[1,0] op_sel_hi:[1,1]
    v_pk_mul_f16 v58, v37, v19 op_sel:[1,0] op_sel_hi:[1,1]
    v_pk_mul_f16 v59, v37, v20 op_sel:[1,0] op_sel_hi:[1,1]
    ds_read_b128 v[88:91], v101 offset:768
    ds_read_b128 v[92:95], v101 offset:784
    ds_read_b128 v[96:99], v101 offset:800
    ds_read_b32 v100, v101 offset:816
    ds_read_b128 v[102:105], v101 offset:128
    ds_read_b128 v[106:109], v101 offset:144
    ds_read_b128 v[110:113], v101 offset:160
    ds_read_b32 v114, v101 offset:176
    v_mfma_f32_32x32x16_f16 v[40:55], v[8:11], v[64:67], v[40:55]
    ds_read_b128 v[4:7], v159 offset:640
    v_pk_mul_f16 v60, v37, v21 op_sel:[1,0] op_sel_hi:[1,1]
    v_pk_mul_f16 v61, v37, v22 op_sel:[1,0] op_sel_hi:[1,1]
    v_pk_mul_f16 v62, v37, v23 op_sel:[1,0] op_sel_hi:[1,1]
    v_pk_mul_f16 v63, v37, v24 op_sel:[1,0] op_sel_hi:[1,1]
    s_waitcnt lgkmcnt(11)
    v_mfma_f32_32x32x16_f16 v[40:55], v[72:75], v[56:59], v[40:55]
    ds_read_b128 v[8:11], v159 offset:656
    v_pk_mul_f16 v64, v37, v25 op_sel:[1,0] op_sel_hi:[1,1]
    v_pk_mul_f16 v65, v37, v26 op_sel:[1,0] op_sel_hi:[1,1]
    v_pk_mul_f16 v66, v37, v27 op_sel:[1,0] op_sel_hi:[1,1]
    v_pk_mul_f16 v67, v37, v28 op_sel:[1,0] op_sel_hi:[1,1]
    v_mfma_f32_32x32x16_f16 v[40:55], v[76:79], v[60:63], v[40:55]
    ds_read_b128 v[72:75], v159 offset:672
    v_pk_mul_f16 v56, v38, v16 op_sel:[0,0] op_sel_hi:[0,1]
    v_pk_mul_f16 v57, v38, v17 op_sel:[0,0] op_sel_hi:[0,1]
    v_pk_mul_f16 v58, v38, v18 op_sel:[0,0] op_sel_hi:[0,1]
    v_pk_mul_f16 v59, v38, v19 op_sel:[0,0] op_sel_hi:[0,1]
    s_waitcnt lgkmcnt(11)
    v_mfma_f32_32x32x16_f16 v[40:55], v[80:83], v[64:67], v[40:55]
    v_pk_mul_f16 v60, v38, v20 op_sel:[0,0] op_sel_hi:[0,1]
    v_pk_mul_f16 v61, v38, v21 op_sel:[0,0] op_sel_hi:[0,1]
    v_pk_mul_f16 v62, v38, v22 op_sel:[0,0] op_sel_hi:[0,1]
    v_pk_mul_f16 v63, v38, v23 op_sel:[0,0] op_sel_hi:[0,1]
    v_mfma_f32_32x32x16_f16 v[40:55], v[84:87], v[56:59], v[40:55]
    v_pk_mul_f16 v64, v38, v24 op_sel:[0,0] op_sel_hi:[0,1]
    v_pk_mul_f16 v65, v38, v25 op_sel:[0,0] op_sel_hi:[0,1]
    v_pk_mul_f16 v66, v38, v26 op_sel:[0,0] op_sel_hi:[0,1]
    v_pk_mul_f16 v67, v38, v27 op_sel:[0,0] op_sel_hi:[0,1]
    s_waitcnt lgkmcnt(1)
    v_mfma_f32_32x32x16_f16 v[40:55], v[4:7], v[60:63], v[40:55]
    v_pk_mul_f16 v68, v38, v28 op_sel:[0,0] op_sel_hi:[0,1]
    v_mfma_f32_32x32x16_f16 v[40:55], v[8:11], v[64:67], v[40:55]
    s_waitcnt lgkmcnt(0)
    v_mfma_f32_32x32x16_f16 v[40:55], v[72:75], v[68:71], v[40:55]
    s_setprio 0
    s_nop 10
    v_ldexp_f32 v40, v40, v102
    v_ldexp_f32 v41, v41, v103
    v_ldexp_f32 v42, v42, v104
    v_ldexp_f32 v43, v43, v105
    v_ldexp_f32 v44, v44, v106
    v_ldexp_f32 v45, v45, v107
    v_ldexp_f32 v46, v46, v108
    v_ldexp_f32 v47, v47, v109
    v_ldexp_f32 v48, v48, v110
    v_ldexp_f32 v49, v49, v111
    v_ldexp_f32 v50, v50, v112
    v_ldexp_f32 v51, v51, v113
    v_ldexp_f32 v52, v52, v114
    v_max3_f32 v65, |v40|, |v41|, |v42|
    v_max3_f32 v65, |v43|, |v44|, v65
    v_max3_f32 v65, |v45|, |v46|, v65
    v_max3_f32 v65, |v47|, |v48|, v65
    v_max3_f32 v65, |v49|, |v50|, v65
    v_max3_f32 v65, |v51|, |v52|, v65
    v_mov_b32 v66, v65
    v_mul_f32 v64, v40, v88
    v_fmac_f32 v64, v41, v89
    v_permlane32_swap_b32 v65, v66
    v_fmac_f32 v64, v42, v90
    v_max_f32 v65, v65, v66
    v_frexp_exp_i32_f32 v65, v65
    v_sub_u32 v30, 8, v65
    v_fmac_f32 v64, v43, v91
    v_fmac_f32 v64, v44, v92
    v_fmac_f32 v64, v45, v93
    v_fmac_f32 v64, v46, v94
    v_fmac_f32 v64, v47, v95
    v_fmac_f32 v64, v48, v96
    v_fmac_f32 v64, v49, v97
    v_fmac_f32 v64, v50, v98
    v_fmac_f32 v64, v51, v99
    v_fmac_f32 v64, v52, v100
    v_ldexp_f32 v40, v40, v30
    v_ldexp_f32 v41, v41, v30
    v_ldexp_f32 v42, v42, v30
    v_ldexp_f32 v43, v43, v30
    v_ldexp_f32 v44, v44, v30
    v_ldexp_f32 v45, v45, v30
    v_ldexp_f32 v46, v46, v30
    v_ldexp_f32 v47, v47, v30
    v_ldexp_f32 v48, v48, v30
    v_ldexp_f32 v49, v49, v30
    v_ldexp_f32 v50, v50, v30
    v_ldexp_f32 v51, v51, v30
    v_ldexp_f32 v52, v52, v30
    v_cvt_pk_f16_f32 v32, v40, v41
    v_cvt_pk_f16_f32 v33, v42, v43
    v_cvt_pk_f16_f32 v34, v44, v45
    v_cvt_pk_f16_f32 v35, v46, v47
    v_cvt_pk_f16_f32 v36, v48, v49
    v_cvt_pk_f16_f32 v37, v50, v51
    v_cvt_pk_f16_f32 v38, v52, v52
    v_ldexp_f32 v64, v64, v13
    v_add_f32 v15, v15, v64
    v_sub_u32 v13, v13, v30
    v_add_u32 v13, v13, v14
    ds_read_b32 v166, v165 offset:8
    s_waitcnt lgkmcnt(0)
    v_readfirstlane_b32 s69, v166
    s_nop 0
    s_cmp_ge_u32 s69, 3
    s_cbranch_scc1 L_ok18
    s_mov_b32 s70, 0x100000
L_sp18:
    s_sleep 1
    ds_read_b32 v166, v165 offset:8
    s_sub_u32 s70, s70, 1
    s_cbranch_scc1 L_ok18
    s_waitcnt lgkmcnt(0)
    v_readfirstlane_b32 s69, v166
    s_nop 0
    s_cmp_ge_u32 s69, 3
    s_cbranch_scc0 L_sp18
L_ok18:
    ds_read_b128 v[72:75], v159 offset:35776
    ds_read_b128 v[76:79], v159 offset:35792
    ds_read_b128 v[80:83], v159 offset:35808
    ds_read_b128 v[84:87], v159 offset:35824
    ds_read_b128 v[4:7], v159 offset:35840
    v_pk_mul_f16 v56, v32, v16 op_sel:[0,0] op_sel_hi:[0,1]
    v_pk_mul_f16 v57, v32, v17 op_sel:[0,0] op_sel_hi:[0,1]
    v_pk_mul_f16 v58, v32, v18 op_sel:[0,0] op_sel_hi:[0,1]
    v_pk_mul_f16 v59, v32, v19 op_sel:[0,0] op_sel_hi:[0,1]
    v_pk_mul_f16 v60, v32, v20 op_sel:[0,0] op_sel_hi:[0,1]
    v_pk_mul_f16 v61, v32, v21 op_sel:[0,0] op_sel_hi:[0,1]
    v_pk_mul_f16 v62, v32, v22 op_sel:[0,0] op_sel_hi:[0,1]
    v_pk_mul_f16 v63, v32, v23 op_sel:[0,0] op_sel_hi:[0,1]
    s_setprio 1
    s_waitcnt lgkmcnt(3)
    v_mfma_f32_32x32x16_f16 v[40:55], v[72:75], v[56:59], 0
    ds_read_b128 v[8:11], v159 offset:35856
    v_pk_mul_f16 v64, v32, v24 op_sel:[0,0] op_sel_hi:[0,1]
    v_pk_mul_f16 v65, v32, v25 op_sel:[0,0] op_sel_hi:[0,1]
    v_pk_mul_f16 v66, v32, v26 op_sel:[0,0] op_sel_hi:[0,1]
    v_pk_mul_f16 v67, v32, v27 op_sel:[0,0] op_sel_hi:[0,1]
    v_mfma_f32_32x32x16_f16 v[40:55], v[76:79], v[60:63], v[40:55]
    ds_read_b128 v[72:75], v159 offset:35872
    v_pk_mul_f16 v56, v32, v28 op_sel:[0,0] op_sel_hi:[0,1]
    v_pk_mul_f16 v57, v32, v16 op_sel:[1,0] op_sel_hi:[1,1]
    v_pk_mul_f16 v58, v32, v17 op_sel:[1,0] op_sel_hi:[1,1]
    v_pk_mul_f16 v59, v32, v18 op_sel:[1,0] op_sel_hi:[1,1]
    s_waitcnt lgkmcnt(3)
    v_mfma_f32_32x32x16_f16 v[40:55], v[80:83], v[64:67], v[40:55]
    ds_read_b128 v[76:79], v159 offset:35888
    v_pk_mul_f16 v60, v32, v19 op_sel:[1,0] op_sel_hi:[1,1]
    v_pk_mul_f16 v61, v32, v20 op_sel:[1,0] op_sel_hi:[1,1]
    v_pk_mul_f16 v62, v32, v21 op_sel:[1,0] op_sel_hi:[1,1]
    v_pk_mul_f16 v63, v32, v22 op_sel:[1,0] op_sel_hi:[1,1]
    s_setprio 2
    v_mfma_f32_32x32x16_f16 v[40:55], v[84:87], v[56:59], v[40:55]
    ds_read_b128 v[80:83], v159 offset:35904
    v_pk_mul_f16 v64, v32, v23 op_sel:[1,0] op_sel_hi:[1,1]
    v_pk_mul_f16 v65, v32, v24 op_sel:[1,0] op_sel_hi:[1,1]
    v_pk_mul_f16 v66, v32, v25 op_sel:[1,0] op_sel_hi:[1,1]
    v_pk_mul_f16 v67, v32, v26 op_sel:[1,0] op_sel_hi:[1,1]
    s_waitcnt lgkmcnt(3)
    v_mfma_f32_32x32x16_f16 v[40:55], v[4:7], v[60:63], v[40:55]
    ds_read_b128 v[84:87], v159 offset:35920
    v_pk_mul_f16 v56, v32, v27 op_sel:[1,0] op_sel_hi:[1,1]
    v_pk_mul_f16 v57, v32, v28 op_sel:[1,0] op_sel_hi:[1,1]
    v_pk_mul_f16 v58, v33, v16 op_sel:[0,0] op_sel_hi:[0,1]
    v_pk_mul_f16 v59, v33, v17 op_sel:[0,0] op_sel_hi:[0,1]
    v_mfma_f32_32x32x16_f16 v[40:55], v[8:11], v[64:67], v[40:55]
    ds_read_b128 v[4:7], v159 offset:35936
    v_pk_mul_f16 v60, v33, v18 op_sel:[0,0] op_sel_hi:[0,1]
    v_pk_mul_f16 v61, v33, v19 op_sel:[0,0] op_sel_hi:[0,1]
    v_pk_mul_f16 v62, v33, v20 op_sel:[0,0] op_sel_hi:[0,1]
    v_pk_mul_f16 v63, v33, v21 op_sel:[0,0] op_sel_hi:[0,1]
    s_waitcnt lgkmcnt(3)
    v_mfma_f32_32x32x16_f16 v[40:55], v[72:75], v[56:59], v[40:55]
    ds_read_b128 v[8:11], v159 offset:35952
    v_pk_mul_f16 v64, v33, v22 op_sel:[0,0] op_sel_hi:[0,1]
    v_pk_mul_f16 v65, v33, v23 op_sel:[0,0] op_sel_hi:[0,1]
    v_pk_mul_f16 v66, v33, v24 op_sel:[0,0] op_sel_hi:[0,1]
    v_pk_mul_f16 v67, v33, v25 op_sel:[0,0] op_sel_hi:[0,1]
    v_mfma_f32_32x32x16_f16 v[40:55], v[76:79], v[60:63], v[40:55]
    ds_read_b128 v[72:75], v159 offset:35968
    v_pk_mul_f16 v56, v33, v26 op_sel:[0,0] op_sel_hi:[0,1]
    v_pk_mul_f16 v57, v33, v27 op_sel:[0,0] op_sel_hi:[0,1]
    v_pk_mul_f16 v58, v33, v28 op_sel:[0,0] op_sel_hi:[0,1]
    v_pk_mul_f16 v59, v33, v16 op_sel:[1,0] op_sel_hi:[1,1]
    s_waitcnt lgkmcnt(3)
    v_mfma_f32_32x32x16_f16 v[40:55], v[80:83], v[64:67], v[40:55]
    ds_read_b128 v[76:79], v159 offset:35984
    v_pk_mul_f16 v60, v33, v17 op_sel:[1,0] op_sel_hi:[1,1]
    v_pk_mul_f16 v61, v33, v18 op_sel:[1,0] op_sel_hi:[1,1]
    v_pk_mul_f16 v62, v33, v19 op_sel:[1,0] op_sel_hi:[1,1]
    v_pk_mul_f16 v63, v33, v20 op_sel:[1,0] op_sel_hi:[1,1]
    v_mfma_f32_32x32x16_f16 v[40:55], v[84:87], v[56:59], v[40:55]
    ds_read_b128 v[80:83], v159 offset:36000
    v_pk_mul_f16 v64, v33, v21 op_sel:[1,0] op_sel_hi:[1,1]
    v_pk_mul_f16 v65, v33, v22 op_sel:[1,0] op_sel_hi:[1,1]
    v_pk_mul_f16 v66, v33, v23 op_sel:[1,0] op_sel_hi:[1,1]
    v_pk_mul_f16 v67, v33, v24 op_sel:[1,0] op_sel_hi:[1,1]
    s_waitcnt lgkmcnt(3)
    v_mfma_f32_32x32x16_f16 v[40:55], v[4:7], v[60:63], v[40:55]
    ds_read_b128 v[84:87], v159 offset:36016
    v_pk_mul_f16 v56, v33, v25 op_sel:[1,0] op_sel_hi:[1,1]
    v_pk_mul_f16 v57, v33, v26 op_sel:[1,0] op_sel_hi:[1,1]
    v_pk_mul_f16 v58, v33, v27 op_sel:[1,0] op_sel_hi:[1,1]
    v_pk_mul_f16 v59, v33, v28 op_sel:[1,0] op_sel_hi:[1,1]
    v_mfma_f32_32x32x16_f16 v[40:55], v[8:11], v[64:67], v[40:55]
    ds_read_b128 v[4:7], v159 offset:36032
    v_pk_mul_f16 v60, v34, v16 op_sel:[0,0] op_sel_hi:[0,1]
    v_pk_mul_f16 v61, v34, v17 op_sel:[0,0] op_sel_hi:[0,1]
    v_pk_mul_f16 v62, v34, v18 op_sel:[0,0] op_sel_hi:[0,1]
    v_pk_mul_f16 v63, v34, v19 op_sel:[0,0] op_sel_hi:[0,1]
    s_waitcnt lgkmcnt(3)
    v_mfma_f32_32x32x16_f16 v[40:55], v[72:75], v[56:59], v[40:55]
    ds_read_b128 v[8:11], v159 offset:36048
    v_pk_mul_f16 v64, v34, v20 op_sel:[0,0] op_sel_hi:[0,1]
    v_pk_mul_f16 v65, v34, v21 op_sel:[0,0] op_sel_hi:[0,1]
    v_pk_mul_f16 v66, v34, v22 op_sel:[0,0] op_sel_hi:[0,1]
    v_pk_mul_f16 v67, v34, v23 op_sel:[0,0] op_sel_hi:[0,1]
    v_mfma_f32_32x32x16_f16 v[40:55], v[76:79], v[60:63], v[40:55]
    ds_read_b128 v[72:75], v159 offset:36064
    v_pk_mul_f16 v56, v34, v24 op_sel:[0,0] op_sel_hi:[0,1]
    v_pk_mul_f16 v57, v34, v25 op_sel:[0,0] op_sel_hi:[0,1]
    v_pk_mul_f16 v58, v34, v26 op_sel:[0,0] op_sel_hi:[0,1]
    v_pk_mul_f16 v59, v34, v27 op_sel:[0,0] op_sel_hi:[0,1]
    s_waitcnt lgkmcnt(3)
    v_mfma_f32_32x32x16_f16 v[40:55], v[80:83], v[64:67], v[40:55]
    ds_read_b128 v[76:79], v159 offset:36080
    v_pk_mul_f16 v60, v34, v28 op_sel:[0,0] op_sel_hi:[0,1]
    v_pk_mul_f16 v61, v34, v16 op_sel:[1,0] op_sel_hi:[1,1]
    v_pk_mul_f16 v62, v34, v17 op_sel:[1,0] op_sel_hi:[1,1]
    v_pk_mul_f16 v63, v34, v18 op_sel:[1,0] op_sel_hi:[1,1]
    v_mfma_f32_32x32x16_f16 v[40:55], v[84:87], v[56:59], v[40:55]
    ds_read_b128 v[80:83], v159 offset:36096
    v_pk_mul_f16 v64, v34, v19 op_sel:[1,0] op_sel_hi:[1,1]
    v_pk_mul_f16 v65, v34, v20 op_sel:[1,0] op_sel_hi:[1,1]
    v_pk_mul_f16 v66, v34, v21 op_sel:[1,0] op_sel_hi:[1,1]
    v_pk_mul_f16 v67, v34, v22 op_sel:[1,0] op_sel_hi:[1,1]
    s_waitcnt lgkmcnt(3)
    v_mfma_f32_32x32x16_f16 v[40:55], v[4:7], v[60:63], v[40:55]
    ds_read_b128 v[84:87], v159 offset:36112
    v_pk_mul_f16 v56, v34, v23 op_sel:[1,0] op_sel_hi:[1,1]
    v_pk_mul_f16 v57, v34, v24 op_sel:[1,0] op_sel_hi:[1,1]
    v_pk_mul_f16 v58, v34, v25 op_sel:[1,0] op_sel_hi:[1,1]
    v_pk_mul_f16 v59, v34, v26 op_sel:[1,0] op_sel_hi:[1,1]
    v_mfma_f32_32x32x16_f16 v[40:55], v[8:11], v[64:67], v[40:55]
    ds_read_b128 v[4:7], v159 offset:36128
    v_pk_mul_f16 v60, v34, v27 op_sel:[1,0] op_sel_hi:[1,1]
    v_pk_mul_f16 v61, v34, v28 op_sel:[1,0] op_sel_hi:[1,1]
    v_pk_mul_f16 v62, v35, v16 op_sel:[0,0] op_sel_hi:[0,1]
    v_pk_mul_f16 v63, v35, v17 op_sel:[0,0] op_sel_hi:[0,1]
    s_waitcnt lgkmcnt(3)
    v_mfma_f32_32x32x16_f16 v[40:55], v[72:75], v[56:59], v[40:55]
    ds_read_b128 v[8:11], v159 offset:36144
    v_pk_mul_f16 v64, v35, v18 op_sel:[0,0] op_sel_hi:[0,1]
    v_pk_mul_f16 v65, v35, v19 op_sel:[0,0] op_sel_hi:[0,1]
    v_pk_mul_f16 v66, v35, v20 op_sel:[0,0] op_sel_hi:[0,1]
    v_pk_mul_f16 v67, v35, v21 op_sel:[0,0] op_sel_hi:[0,1]
    v_mfma_f32_32x32x16_f16 v[40:55], v[76:79], v[60:63], v[40:55]
    ds_read_b128 v[72:75], v159 offset:36160
    v_pk_mul_f16 v56, v35, v22 op_sel:[0,0] op_sel_hi:[0,1]
    v_pk_mul_f16 v57, v35, v23 op_sel:[0,0] op_sel_hi:[0,1]
    v_pk_mul_f16 v58, v35, v24 op_sel:[0,0] op_sel_hi:[0,1]
    v_pk_mul_f16 v59, v35, v25 op_sel:[0,0] op_sel_hi:[0,1]
    s_waitcnt lgkmcnt(3)
    v_mfma_f32_32x32x16_f16 v[40:55], v[80:83], v[64:67], v[40:55]
    ds_read_b128 v[76:79], v159 offset:36176
    v_pk_mul_f16 v60, v35, v26 op_sel:[0,0] op_sel_hi:[0,1]
    v_pk_mul_f16 v61, v35, v27 op_sel:[0,0] op_sel_hi:[0,1]
    v_pk_mul_f16 v62, v35, v28 op_sel:[0,0] op_sel_hi:[0,1]
    v_pk_mul_f16 v63, v35, v16 op_sel:[1,0] op_sel_hi:[1,1]
    v_mfma_f32_32x32x16_f16 v[40:55], v[84:87], v[56:59], v[40:55]
    ds_read_b128 v[80:83], v159 offset:36192
    v_pk_mul_f16 v64, v35, v17 op_sel:[1,0] op_sel_hi:[1,1]
    v_pk_mul_f16 v65, v35, v18 op_sel:[1,0] op_sel_hi:[1,1]
    v_pk_mul_f16 v66, v35, v19 op_sel:[1,0] op_sel_hi:[1,1]
    v_pk_mul_f16 v67, v35, v20 op_sel:[1,0] op_sel_hi:[1,1]
    s_waitcnt lgkmcnt(3)
    v_mfma_f32_32x32x16_f16 v[40:55], v[4:7], v[60:63], v[40:55]
    ds_read_b128 v[84:87], v159 offset:36208
    v_pk_mul_f16 v56, v35, v21 op_sel:[1,0] op_sel_hi:[1,1]
    v_pk_mul_f16 v57, v35, v22 op_sel:[1,0] op_sel_hi:[1,1]
    v_pk_mul_f16 v58, v35, v23 op_sel:[1,0] op_sel_hi:[1,1]
    v_pk_mul_f16 v59, v35, v24 op_sel:[1,0] op_sel_hi:[1,1]
    v_mfma_f32_32x32x16_f16 v[40:55], v[8:11], v[64:67], v[40:55]
    ds_read_b128 v[4:7], v159 offset:36224
    v_pk_mul_f16 v60, v35, v25 op_sel:[1,0] op_sel_hi:[1,1]
    v_pk_mul_f16 v61, v35, v26 op_sel:[1,0] op_sel_hi:[1,1]
    v_pk_mul_f16 v62, v35, v27 op_sel:[1,0] op_sel_hi:[1,1]
    v_pk_mul_f16 v63, v35, v28 op_sel:[1,0] op_sel_hi:[1,1]
    s_waitcnt lgkmcnt(3)
    v_mfma_f32_32x32x16_f16 v[40:55], v[72:75], v[56:59], v[40:55]
    ds_read_b128 v[8:11], v159 offset:36240
    v_pk_mul_f16 v64, v36, v16 op_sel:[0,0] op_sel_hi:[0,1]
    v_pk_mul_f16 v65, v36, v17 op_sel:[0,0] op_sel_hi:[0,1]
    v_pk_mul_f16 v66, v36, v18 op_sel:[0,0] op_sel_hi:[0,1]
    v_pk_mul_f16 v67, v36, v19 op_sel:[0,0] op_sel_hi:[0,1]
    v_mfma_f32_32x32x16_f16 v[40:55], v[76:79], v[60:63], v[40:55]
    ds_read_b128 v[72:75], v159 offset:36256
    v_pk_mul_f16 v56, v36, v20 op_sel:[0,0] op_sel_hi:[0,1]
    v_pk_mul_f16 v57, v36, v21 op_sel:[0,0] op_sel_hi:[0,1]
    v_pk_mul_f16 v58, v36, v22 op_sel:[0,0] op_sel_hi:[0,1]
    v_pk_mul_f16 v59, v36, v23 op_sel:[0,0] op_sel_hi:[0,1]
    s_waitcnt lgkmcnt(3)
    v_mfma_f32_32x32x16_f16 v[40:55], v[80:83], v[64:67], v[40:55]
    ds_read_b128 v[76:79], v159 offset:36272
    v_pk_mul_f16 v60, v36, v24 op_sel:[0,0] op_sel_hi:[0,1]
    v_pk_mul_f16 v61, v36, v25 op_sel:[0,0] op_sel_hi:[0,1]
    v_pk_mul_f16 v62, v36, v26 op_sel:[0,0] op_sel_hi:[0,1]
    v_pk_mul_f16 v63, v36, v27 op_sel:[0,0] op_sel_hi:[0,1]
    v_mfma_f32_32x32x16_f16 v[40:55], v[84:87], v[56:59], v[40:55]
    ds_read_b128 v[80:83], v159 offset:36288
    v_pk_mul_f16 v64, v36, v28 op_sel:[0,0] op_sel_hi:[0,1]
    v_pk_mul_f16 v65, v36, v16 op_sel:[1,0] op_sel_hi:[1,1]
    v_pk_mul_f16 v66, v36, v17 op_sel:[1,0] op_sel_hi:[1,1]
    v_pk_mul_f16 v67, v36, v18 op_sel:[1,0] op_sel_hi:[1,1]
    s_waitcnt lgkmcnt(3)
    v_mfma_f32_32x32x16_f16 v[40:55], v[4:7], v[60:63], v[40:55]
    ds_read_b128 v[84:87], v159 offset:36304
    v_pk_mul_f16 v56, v36, v19 op_sel:[1,0] op_sel_hi:[1,1]
    v_pk_mul_f16 v57, v36, v20 op_sel:[1,0] op_sel_hi:[1,1]
    v_pk_mul_f16 v58, v36, v21 op_sel:[1,0] op_sel_hi:[1,1]
    v_pk_mul_f16 v59, v36, v22 op_sel:[1,0] op_sel_hi:[1,1]
    v_mfma_f32_32x32x16_f16 v[40:55], v[8:11], v[64:67], v[40:55]
    ds_read_b128 v[4:7], v159 offset:36320
    v_pk_mul_f16 v60, v36, v23 op_sel:[1,0] op_sel_hi:[1,1]
    v_pk_mul_f16 v61, v36, v24 op_sel:[1,0] op_sel_hi:[1,1]
    v_pk_mul_f16 v62, v36, v25 op_sel:[1,0] op_sel_hi:[1,1]
    v_pk_mul_f16 v63, v36, v26 op_sel:[1,0] op_sel_hi:[1,1]
    s_waitcnt lgkmcnt(3)
    v_mfma_f32_32x32x16_f16 v[40:55], v[72:75], v[56:59], v[40:55]
    ds_read_b128 v[8:11], v159 offset:36336
    v_pk_mul_f16 v64, v36, v27 op_sel:[1,0] op_sel_hi:[1,1]
    v_pk_mul_f16 v65, v36, v28 op_sel:[1,0] op_sel_hi:[1,1]
    v_pk_mul_f16 v66, v37, v16 op_sel:[0,0] op_sel_hi:[0,1]
    v_pk_mul_f16 v67, v37, v17 op_sel:[0,0] op_sel_hi:[0,1]
    v_mfma_f32_32x32x16_f16 v[40:55], v[76:79], v[60:63], v[40:55]
    ds_read_b128 v[72:75], v159 offset:36352
    v_pk_mul_f16 v56, v37, v18 op_sel:[0,0] op_sel_hi:[0,1]
    v_pk_mul_f16 v57, v37, v19 op_sel:[0,0] op_sel_hi:[0,1]
    v_pk_mul_f16 v58, v37, v20 op_sel:[0,0] op_sel_hi:[0,1]
    v_pk_mul_f16 v59, v37, v21 op_sel:[0,0] op_sel_hi:[0,1]
    s_waitcnt lgkmcnt(3)
    v_mfma_f32_32x32x16_f16 v[40:55], v[80:83], v[64:67], v[40:55]
    ds_read_b128 v[76:79], v159 offset:36368
    v_pk_mul_f16 v60, v37, v22 op_sel:[0,0] op_sel_hi:[0,1]
    v_pk_mul_f16 v61, v37, v23 op_sel:[0,0] op_sel_hi:[0,1]
    v_pk_mul_f16 v62, v37, v24 op_sel:[0,0] op_sel_hi:[0,1]
    v_pk_mul_f16 v63, v37, v25 op_sel:[0,0] op_sel_hi:[0,1]
    v_mfma_f32_32x32x16_f16 v[40:55], v[84:87], v[56:59], v[40:55]
    ds_read_b128 v[80:83], v159 offset:36384
    v_pk_mul_f16 v64, v37, v26 op_sel:[0,0] op_sel_hi:[0,1]
    v_pk_mul_f16 v65, v37, v27 op_sel:[0,0] op_sel_hi:[0,1]
    v_pk_mul_f16 v66, v37, v28 op_sel:[0,0] op_sel_hi:[0,1]
    v_pk_mul_f16 v67, v37, v16 op_sel:[1,0] op_sel_hi:[1,1]
    s_waitcnt lgkmcnt(3)
    v_mfma_f32_32x32x16_f16 v[40:55], v[4:7], v[60:63], v[40:55]
    ds_read_b128 v[84:87], v159 offset:36400
    v_pk_mul_f16 v56, v37, v17 op_sel:[1,0] op_sel_hi:[1,1]
    v_pk_mul_f16 v57, v37, v18 op_sel:[1,0] op_sel_hi:[1,1]
    v_pk_mul_f16 v58, v37, v19 op_sel:[1,0] op_sel_hi:[1,1]
    v_pk_mul_f16 v59, v37, v20 op_sel:[1,0] op_sel_hi:[1,1]
    ds_read_b128 v[88:91], v101 offset:896
    ds_read_b128 v[92:95], v101 offset:912
    ds_read_b128 v[96:99], v101 offset:928
    ds_read_b32 v100, v101 offset:944
    ds_read_b128 v[102:105], v101 offset:256
    ds_read_b128 v[106:109], v101 offset:272
    ds_read_b128 v[110:113], v101 offset:288
    ds_read_b32 v114, v101 offset:304
    v_mfma_f32_32x32x16_f16 v[40:55], v[8:11], v[64:67], v[40:55]
    ds_read_b128 v[4:7], v159 offset:36416
    v_pk_mul_f16 v60, v37, v21 op_sel:[1,0] op_sel_hi:[1,1]
    v_pk_mul_f16 v61, v37, v22 op_sel:[1,0] op_sel_hi:[1,1]
    v_pk_mul_f16 v62, v37, v23 op_sel:[1,0] op_sel_hi:[1,1]
    v_pk_mul_f16 v63, v37, v24 op_sel:[1,0] op_sel_hi:[1,1]
    s_waitcnt lgkmcnt(11)
    v_mfma_f32_32x32x16_f16 v[40:55], v[72:75], v[56:59], v[40:55]
    ds_read_b128 v[8:11], v159 offset:36432
    v_pk_mul_f16 v64, v37, v25 op_sel:[1,0] op_sel_hi:[1,1]
    v_pk_mul_f16 v65, v37, v26 op_sel:[1,0] op_sel_hi:[1,1]
    v_pk_mul_f16 v66, v37, v27 op_sel:[1,0] op_sel_hi:[1,1]
    v_pk_mul_f16 v67, v37, v28 op_sel:[1,0] op_sel_hi:[1,1]
    v_mfma_f32_32x32x16_f16 v[40:55], v[76:79], v[60:63], v[40:55]
    ds_read_b128 v[72:75], v159 offset:36448
    v_pk_mul_f16 v56, v38, v16 op_sel:[0,0] op_sel_hi:[0,1]
    v_pk_mul_f16 v57, v38, v17 op_sel:[0,0] op_sel_hi:[0,1]
    v_pk_mul_f16 v58, v38, v18 op_sel:[0,0] op_sel_hi:[0,1]
    v_pk_mul_f16 v59, v38, v19 op_sel:[0,0] op_sel_hi:[0,1]
    s_waitcnt lgkmcnt(11)
    v_mfma_f32_32x32x16_f16 v[40:55], v[80:83], v[64:67], v[40:55]
    v_pk_mul_f16 v60, v38, v20 op_sel:[0,0] op_sel_hi:[0,1]
    v_pk_mul_f16 v61, v38, v21 op_sel:[0,0] op_sel_hi:[0,1]
    v_pk_mul_f16 v62, v38, v22 op_sel:[0,0] op_sel_hi:[0,1]
    v_pk_mul_f16 v63, v38, v23 op_sel:[0,0] op_sel_hi:[0,1]
    v_mfma_f32_32x32x16_f16 v[40:55], v[84:87], v[56:59], v[40:55]
    v_pk_mul_f16 v64, v38, v24 op_sel:[0,0] op_sel_hi:[0,1]
    v_pk_mul_f16 v65, v38, v25 op_sel:[0,0] op_sel_hi:[0,1]
    v_pk_mul_f16 v66, v38, v26 op_sel:[0,0] op_sel_hi:[0,1]
    v_pk_mul_f16 v67, v38, v27 op_sel:[0,0] op_sel_hi:[0,1]
    s_waitcnt lgkmcnt(1)
    v_mfma_f32_32x32x16_f16 v[40:55], v[4:7], v[60:63], v[40:55]
    v_pk_mul_f16 v68, v38, v28 op_sel:[0,0] op_sel_hi:[0,1]
    v_mfma_f32_32x32x16_f16 v[40:55], v[8:11], v[64:67], v[40:55]
    s_waitcnt lgkmcnt(0)
    v_mfma_f32_32x32x16_f16 v[40:55], v[72:75], v[68:71], v[40:55]
    s_setprio 0
    s_nop 10
    v_ldexp_f32 v40, v40, v102
    v_ldexp_f32 v41, v41, v103
    v_ldexp_f32 v42, v42, v104
    v_ldexp_f32 v43, v43, v105
    v_ldexp_f32 v44, v44, v106
    v_ldexp_f32 v45, v45, v107
    v_ldexp_f32 v46, v46, v108
    v_ldexp_f32 v47, v47, v109
    v_ldexp_f32 v48, v48, v110
    v_ldexp_f32 v49, v49, v111
    v_ldexp_f32 v50, v50, v112
    v_ldexp_f32 v51, v51, v113
    v_ldexp_f32 v52, v52, v114
    v_max3_f32 v65, |v40|, |v41|, |v42|
    v_max3_f32 v65, |v43|, |v44|, v65
    v_max3_f32 v65, |v45|, |v46|, v65
    v_max3_f32 v65, |v47|, |v48|, v65
    v_max3_f32 v65, |v49|, |v50|, v65
    v_max3_f32 v65, |v51|, |v52|, v65
    v_mov_b32 v66, v65
    v_mul_f32 v64, v40, v88
    v_fmac_f32 v64, v41, v89
    v_permlane32_swap_b32 v65, v66
    v_fmac_f32 v64, v42, v90
    v_max_f32 v65, v65, v66
    v_frexp_exp_i32_f32 v65, v65
    v_sub_u32 v30, 8, v65
    v_fmac_f32 v64, v43, v91
    v_fmac_f32 v64, v44, v92
    v_fmac_f32 v64, v45, v93
    v_fmac_f32 v64, v46, v94
    v_fmac_f32 v64, v47, v95
    v_fmac_f32 v64, v48, v96
    v_fmac_f32 v64, v49, v97
    v_fmac_f32 v64, v50, v98
    v_fmac_f32 v64, v51, v99
    v_fmac_f32 v64, v52, v100
    v_ldexp_f32 v40, v40, v30
    v_ldexp_f32 v41, v41, v30
    v_ldexp_f32 v42, v42, v30
    v_ldexp_f32 v43, v43, v30
    v_ldexp_f32 v44, v44, v30
    v_ldexp_f32 v45, v45, v30
    v_ldexp_f32 v46, v46, v30
    v_ldexp_f32 v47, v47, v30
    v_ldexp_f32 v48, v48, v30
    v_ldexp_f32 v49, v49, v30
    v_ldexp_f32 v50, v50, v30
    v_ldexp_f32 v51, v51, v30
    v_ldexp_f32 v52, v52, v30
    v_cvt_pk_f16_f32 v32, v40, v41
    v_cvt_pk_f16_f32 v33, v42, v43
    v_cvt_pk_f16_f32 v34, v44, v45
    v_cvt_pk_f16_f32 v35, v46, v47
    v_cvt_pk_f16_f32 v36, v48, v49
    v_cvt_pk_f16_f32 v37, v50, v51
    v_cvt_pk_f16_f32 v38, v52, v52
    v_ldexp_f32 v64, v64, v13
    v_add_f32 v15, v15, v64
    v_sub_u32 v13, v13, v30
    v_add_u32 v13, v13, v14
    ds_read_b32 v166, v165 offset:8
    s_waitcnt lgkmcnt(0)
    v_readfirstlane_b32 s69, v166
    s_nop 0
    s_cmp_ge_u32 s69, 4
    s_cbranch_scc1 L_ok19
    s_mov_b32 s70, 0x100000
L_sp19:
    s_sleep 1
    ds_read_b32 v166, v165 offset:8
    s_sub_u32 s70, s70, 1
    s_cbranch_scc1 L_ok19
    s_waitcnt lgkmcnt(0)
    v_readfirstlane_b32 s69, v166
    s_nop 0
    s_cmp_ge_u32 s69, 4
    s_cbranch_scc0 L_sp19
L_ok19:
    ds_read_b128 v[72:75], v160 offset:0
    ds_read_b128 v[76:79], v160 offset:16
    ds_read_b128 v[80:83], v160 offset:32
    ds_read_b128 v[84:87], v160 offset:48
    ds_read_b128 v[4:7], v160 offset:64
    ds_read_b32 v166, v165 offset:8
    s_waitcnt lgkmcnt(0)
    v_readfirstlane_b32 s69, v166
    s_nop 0
    s_cmp_ge_u32 s69, 5
    s_cbranch_scc1 L_ok20
    s_mov_b32 s70, 0x100000
L_sp20:
    s_sleep 1
    ds_read_b32 v166, v165 offset:8
    s_sub_u32 s70, s70, 1
    s_cbranch_scc1 L_ok20
    s_waitcnt lgkmcnt(0)
    v_readfirstlane_b32 s69, v166
    s_nop 0
    s_cmp_ge_u32 s69, 5
    s_cbranch_scc0 L_sp20
L_ok20:
    v_add_u32 v2, 156672, v31
    ds_read_b128 v[132:135], v2 offset:0
    ds_read_b128 v[136:139], v2 offset:1024
    ds_read_b128 v[140:143], v2 offset:2048
    ds_read_b128 v[144:147], v2 offset:3072
    ds_read_b128 v[116:119], v101 offset:1024
    ds_read_b128 v[120:123], v101 offset:1040
    ds_read_b128 v[124:127], v101 offset:1056
    ds_read_b128 v[128:131], v101 offset:1072
    v_pk_mul_f16 v56, v32, v16 op_sel:[0,0] op_sel_hi:[0,1]
    v_pk_mul_f16 v57, v32, v17 op_sel:[0,0] op_sel_hi:[0,1]
    v_pk_mul_f16 v58, v32, v18 op_sel:[0,0] op_sel_hi:[0,1]
    v_pk_mul_f16 v59, v32, v19 op_sel:[0,0] op_sel_hi:[0,1]
    v_pk_mul_f16 v60, v32, v20 op_sel:[0,0] op_sel_hi:[0,1]
    v_pk_mul_f16 v61, v32, v21 op_sel:[0,0] op_sel_hi:[0,1]
    v_pk_mul_f16 v62, v32, v22 op_sel:[0,0] op_sel_hi:[0,1]
    v_pk_mul_f16 v63, v32, v23 op_sel:[0,0] op_sel_hi:[0,1]
    s_setprio 1
    v_mfma_f32_32x32x16_f16 v[40:55], v[72:75], v[56:59], 0
    ds_read_b128 v[8:11], v160 offset:80
    v_pk_mul_f16 v64, v32, v24 op_sel:[0,0] op_sel_hi:[0,1]
    v_pk_mul_f16 v65, v32, v25 op_sel:[0,0] op_sel_hi:[0,1]
    v_pk_mul_f16 v66, v32, v26 op_sel:[0,0] op_sel_hi:[0,1]
    v_pk_mul_f16 v67, v32, v27 op_sel:[0,0] op_sel_hi:[0,1]
    v_mfma_f32_32x32x16_f16 v[40:55], v[76:79], v[60:63], v[40:55]
    ds_read_b128 v[72:75], v160 offset:96
    v_pk_mul_f16 v56, v32, v28 op_sel:[0,0] op_sel_hi:[0,1]
    v_pk_mul_f16 v57, v32, v16 op_sel:[1,0] op_sel_hi:[1,1]
    v_pk_mul_f16 v58, v32, v17 op_sel:[1,0] op_sel_hi:[1,1]
    v_pk_mul_f16 v59, v32, v18 op_sel:[1,0] op_sel_hi:[1,1]
    v_mfma_f32_32x32x16_f16 v[40:55], v[80:83], v[64:67], v[40:55]
    ds_read_b128 v[76:79], v160 offset:112
    v_pk_mul_f16 v60, v32, v19 op_sel:[1,0] op_sel_hi:[1,1]
    v_pk_mul_f16 v61, v32, v20 op_sel:[1,0] op_sel_hi:[1,1]
    v_pk_mul_f16 v62, v32, v21 op_sel:[1,0] op_sel_hi:[1,1]
    v_pk_mul_f16 v63, v32, v22 op_sel:[1,0] op_sel_hi:[1,1]
    s_setprio 2
    v_mfma_f32_32x32x16_f16 v[40:55], v[84:87], v[56:59], v[40:55]
    ds_read_b128 v[80:83], v160 offset:128
    v_pk_mul_f16 v64, v32, v23 op_sel:[1,0] op_sel_hi:[1,1]
    v_pk_mul_f16 v65, v32, v24 op_sel:[1,0] op_sel_hi:[1,1]
    v_pk_mul_f16 v66, v32, v25 op_sel:[1,0] op_sel_hi:[1,1]
    v_pk_mul_f16 v67, v32, v26 op_sel:[1,0] op_sel_hi:[1,1]
    s_waitcnt lgkmcnt(3)
    v_mfma_f32_32x32x16_f16 v[40:55], v[4:7], v[60:63], v[40:55]
    ds_read_b128 v[84:87], v160 offset:144
    v_pk_mul_f16 v56, v32, v27 op_sel:[1,0] op_sel_hi:[1,1]
    v_pk_mul_f16 v57, v32, v28 op_sel:[1,0] op_sel_hi:[1,1]
    v_pk_mul_f16 v58, v33, v16 op_sel:[0,0] op_sel_hi:[0,1]
    v_pk_mul_f16 v59, v33, v17 op_sel:[0,0] op_sel_hi:[0,1]
    ds_read_b32 v148, v39 offset:0
    ds_read_b32 v149, v39 offset:128
    ds_read_b32 v150, v39 offset:256
    ds_read_b32 v151, v39 offset:384
    v_mfma_f32_32x32x16_f16 v[40:55], v[8:11], v[64:67], v[40:55]
    ds_read_b128 v[4:7], v160 offset:160
    v_pk_mul_f16 v60, v33, v18 op_sel:[0,0] op_sel_hi:[0,1]
    v_pk_mul_f16 v61, v33, v19 op_sel:[0,0] op_sel_hi:[0,1]
    v_pk_mul_f16 v62, v33, v20 op_sel:[0,0] op_sel_hi:[0,1]
    v_pk_mul_f16 v63, v33, v21 op_sel:[0,0] op_sel_hi:[0,1]
    s_waitcnt lgkmcnt(7)
    v_mfma_f32_32x32x16_f16 v[40:55], v[72:75], v[56:59], v[40:55]
    ds_read_b128 v[8:11], v160 offset:176
    v_pk_mul_f16 v64, v33, v22 op_sel:[0,0] op_sel_hi:[0,1]
    v_pk_mul_f16 v65, v33, v23 op_sel:[0,0] op_sel_hi:[0,1]
    v_pk_mul_f16 v66, v33, v24 op_sel:[0,0] op_sel_hi:[0,1]
    v_pk_mul_f16 v67, v33, v25 op_sel:[0,0] op_sel_hi:[0,1]
    v_mfma_f32_32x32x16_f16 v[40:55], v[76:79], v[60:63], v[40:55]
    ds_read_b128 v[72:75], v160 offset:192
    v_pk_mul_f16 v56, v33, v26 op_sel:[0,0] op_sel_hi:[0,1]
    v_pk_mul_f16 v57, v33, v27 op_sel:[0,0] op_sel_hi:[0,1]
    v_pk_mul_f16 v58, v33, v28 op_sel:[0,0] op_sel_hi:[0,1]
    v_pk_mul_f16 v59, v33, v16 op_sel:[1,0] op_sel_hi:[1,1]
    s_waitcnt lgkmcnt(7)
    v_mfma_f32_32x32x16_f16 v[40:55], v[80:83], v[64:67], v[40:55]
    ds_read_b128 v[76:79], v160 offset:208
    v_pk_mul_f16 v60, v33, v17 op_sel:[1,0] op_sel_hi:[1,1]
    v_pk_mul_f16 v61, v33, v18 op_sel:[1,0] op_sel_hi:[1,1]
    v_pk_mul_f16 v62, v33, v19 op_sel:[1,0] op_sel_hi:[1,1]
    v_pk_mul_f16 v63, v33, v20 op_sel:[1,0] op_sel_hi:[1,1]
    v_mfma_f32_32x32x16_f16 v[40:55], v[84:87], v[56:59], v[40:55]
    ds_read_b128 v[80:83], v160 offset:224
    v_pk_mul_f16 v64, v33, v21 op_sel:[1,0] op_sel_hi:[1,1]
    v_pk_mul_f16 v65, v33, v22 op_sel:[1,0] op_sel_hi:[1,1]
    v_pk_mul_f16 v66, v33, v23 op_sel:[1,0] op_sel_hi:[1,1]
    v_pk_mul_f16 v67, v33, v24 op_sel:[1,0] op_sel_hi:[1,1]
    s_waitcnt lgkmcnt(5)
    v_mfma_f32_32x32x16_bf16 v[116:131], v[132:135], v[148:151], v[116:131]
    s_waitcnt lgkmcnt(3)
    v_mfma_f32_32x32x16_f16 v[40:55], v[4:7], v[60:63], v[40:55]
    ds_read_b128 v[84:87], v160 offset:240
    v_pk_mul_f16 v56, v33, v25 op_sel:[1,0] op_sel_hi:[1,1]
    v_pk_mul_f16 v57, v33, v26 op_sel:[1,0] op_sel_hi:[1,1]
    v_pk_mul_f16 v58, v33, v27 op_sel:[1,0] op_sel_hi:[1,1]
    v_pk_mul_f16 v59, v33, v28 op_sel:[1,0] op_sel_hi:[1,1]
    v_mfma_f32_32x32x16_f16 v[40:55], v[8:11], v[64:67], v[40:55]
    ds_read_b128 v[4:7], v160 offset:256
    v_pk_mul_f16 v60, v34, v16 op_sel:[0,0] op_sel_hi:[0,1]
    v_pk_mul_f16 v61, v34, v17 op_sel:[0,0] op_sel_hi:[0,1]
    v_pk_mul_f16 v62, v34, v18 op_sel:[0,0] op_sel_hi:[0,1]
    v_pk_mul_f16 v63, v34, v19 op_sel:[0,0] op_sel_hi:[0,1]
    ds_read_b32 v148, v39 offset:512
    ds_read_b32 v149, v39 offset:640
    ds_read_b32 v150, v39 offset:768
    ds_read_b32 v151, v39 offset:896
    s_waitcnt lgkmcnt(7)
    v_mfma_f32_32x32x16_f16 v[40:55], v[72:75], v[56:59], v[40:55]
    ds_read_b128 v[8:11], v160 offset:272
    v_pk_mul_f16 v64, v34, v20 op_sel:[0,0] op_sel_hi:[0,1]
    v_pk_mul_f16 v65, v34, v21 op_sel:[0,0] op_sel_hi:[0,1]
    v_pk_mul_f16 v66, v34, v22 op_sel:[0,0] op_sel_hi:[0,1]
    v_pk_mul_f16 v67, v34, v23 op_sel:[0,0] op_sel_hi:[0,1]
    v_mfma_f32_32x32x16_f16 v[40:55], v[76:79], v[60:63], v[40:55]
    ds_read_b128 v[72:75], v160 offset:288
    v_pk_mul_f16 v56, v34, v24 op_sel:[0,0] op_sel_hi:[0,1]
    v_pk_mul_f16 v57, v34, v25 op_sel:[0,0] op_sel_hi:[0,1]
    v_pk_mul_f16 v58, v34, v26 op_sel:[0,0] op_sel_hi:[0,1]
    v_pk_mul_f16 v59, v34, v27 op_sel:[0,0] op_sel_hi:[0,1]
    s_waitcnt lgkmcnt(7)
    v_mfma_f32_32x32x16_f16 v[40:55], v[80:83], v[64:67], v[40:55]
    ds_read_b128 v[76:79], v160 offset:304
    v_pk_mul_f16 v60, v34, v28 op_sel:[0,0] op_sel_hi:[0,1]
    v_pk_mul_f16 v61, v34, v16 op_sel:[1,0] op_sel_hi:[1,1]
    v_pk_mul_f16 v62, v34, v17 op_sel:[1,0] op_sel_hi:[1,1]
    v_pk_mul_f16 v63, v34, v18 op_sel:[1,0] op_sel_hi:[1,1]
    v_mfma_f32_32x32x16_f16 v[40:55], v[84:87], v[56:59], v[40:55]
    ds_read_b128 v[80:83], v160 offset:320
    v_pk_mul_f16 v64, v34, v19 op_sel:[1,0] op_sel_hi:[1,1]
    v_pk_mul_f16 v65, v34, v20 op_sel:[1,0] op_sel_hi:[1,1]
    v_pk_mul_f16 v66, v34, v21 op_sel:[1,0] op_sel_hi:[1,1]
    v_pk_mul_f16 v67, v34, v22 op_sel:[1,0] op_sel_hi:[1,1]
    s_waitcnt lgkmcnt(3)
    v_mfma_f32_32x32x16_f16 v[40:55], v[4:7], v[60:63], v[40:55]
    ds_read_b128 v[84:87], v160 offset:336
    v_pk_mul_f16 v56, v34, v23 op_sel:[1,0] op_sel_hi:[1,1]
    v_pk_mul_f16 v57, v34, v24 op_sel:[1,0] op_sel_hi:[1,1]
    v_pk_mul_f16 v58, v34, v25 op_sel:[1,0] op_sel_hi:[1,1]
    v_pk_mul_f16 v59, v34, v26 op_sel:[1,0] op_sel_hi:[1,1]
    v_mfma_f32_32x32x16_bf16 v[116:131], v[136:139], v[148:151], v[116:131]
    v_mfma_f32_32x32x16_f16 v[40:55], v[8:11], v[64:67], v[40:55]
    ds_read_b128 v[4:7], v160 offset:352
    v_pk_mul_f16 v60, v34, v27 op_sel:[1,0] op_sel_hi:[1,1]
    v_pk_mul_f16 v61, v34, v28 op_sel:[1,0] op_sel_hi:[1,1]
    v_pk_mul_f16 v62, v35, v16 op_sel:[0,0] op_sel_hi:[0,1]
    v_pk_mul_f16 v63, v35, v17 op_sel:[0,0] op_sel_hi:[0,1]
    s_waitcnt lgkmcnt(3)
    v_mfma_f32_32x32x16_f16 v[40:55], v[72:75], v[56:59], v[40:55]
    ds_read_b128 v[8:11], v160 offset:368
    v_pk_mul_f16 v64, v35, v18 op_sel:[0,0] op_sel_hi:[0,1]
    v_pk_mul_f16 v65, v35, v19 op_sel:[0,0] op_sel_hi:[0,1]
    v_pk_mul_f16 v66, v35, v20 op_sel:[0,0] op_sel_hi:[0,1]
    v_pk_mul_f16 v67, v35, v21 op_sel:[0,0] op_sel_hi:[0,1]
    ds_read_b32 v148, v39 offset:1024
    ds_read_b32 v149, v39 offset:1152
    ds_read_b32 v150, v39 offset:1280
    ds_read_b32 v151, v39 offset:1408
    v_mfma_f32_32x32x16_f16 v[40:55], v[76:79], v[60:63], v[40:55]
    ds_read_b128 v[72:75], v160 offset:384
    v_pk_mul_f16 v56, v35, v22 op_sel:[0,0] op_sel_hi:[0,1]
    v_pk_mul_f16 v57, v35, v23 op_sel:[0,0] op_sel_hi:[0,1]
    v_pk_mul_f16 v58, v35, v24 op_sel:[0,0] op_sel_hi:[0,1]
    v_pk_mul_f16 v59, v35, v25 op_sel:[0,0] op_sel_hi:[0,1]
    s_waitcnt lgkmcnt(7)
    v_mfma_f32_32x32x16_f16 v[40:55], v[80:83], v[64:67], v[40:55]
    ds_read_b128 v[76:79], v160 offset:400
    v_pk_mul_f16 v60, v35, v26 op_sel:[0,0] op_sel_hi:[0,1]
    v_pk_mul_f16 v61, v35, v27 op_sel:[0,0] op_sel_hi:[0,1]
    v_pk_mul_f16 v62, v35, v28 op_sel:[0,0] op_sel_hi:[0,1]
    v_pk_mul_f16 v63, v35, v16 op_sel:[1,0] op_sel_hi:[1,1]
    v_mfma_f32_32x32x16_f16 v[40:55], v[84:87], v[56:59], v[40:55]
    ds_read_b128 v[80:83], v160 offset:416
    v_pk_mul_f16 v64, v35, v17 op_sel:[1,0] op_sel_hi:[1,1]
    v_pk_mul_f16 v65, v35, v18 op_sel:[1,0] op_sel_hi:[1,1]
    v_pk_mul_f16 v66, v35, v19 op_sel:[1,0] op_sel_hi:[1,1]
    v_pk_mul_f16 v67, v35, v20 op_sel:[1,0] op_sel_hi:[1,1]
    s_waitcnt lgkmcnt(7)
    v_mfma_f32_32x32x16_f16 v[40:55], v[4:7], v[60:63], v[40:55]
    ds_read_b128 v[84:87], v160 offset:432
    v_pk_mul_f16 v56, v35, v21 op_sel:[1,0] op_sel_hi:[1,1]
    v_pk_mul_f16 v57, v35, v22 op_sel:[1,0] op_sel_hi:[1,1]
    v_pk_mul_f16 v58, v35, v23 op_sel:[1,0] op_sel_hi:[1,1]
    v_pk_mul_f16 v59, v35, v24 op_sel:[1,0] op_sel_hi:[1,1]
    v_mfma_f32_32x32x16_f16 v[40:55], v[8:11], v[64:67], v[40:55]
    ds_read_b128 v[4:7], v160 offset:448
    v_pk_mul_f16 v60, v35, v25 op_sel:[1,0] op_sel_hi:[1,1]
    v_pk_mul_f16 v61, v35, v26 op_sel:[1,0] op_sel_hi:[1,1]
    v_pk_mul_f16 v62, v35, v27 op_sel:[1,0] op_sel_hi:[1,1]
    v_pk_mul_f16 v63, v35, v28 op_sel:[1,0] op_sel_hi:[1,1]
    s_waitcnt lgkmcnt(5)
    v_mfma_f32_32x32x16_bf16 v[116:131], v[140:143], v[148:151], v[116:131]
    s_waitcnt lgkmcnt(3)
    v_mfma_f32_32x32x16_f16 v[40:55], v[72:75], v[56:59], v[40:55]
    ds_read_b128 v[8:11], v160 offset:464
    v_pk_mul_f16 v64, v36, v16 op_sel:[0,0] op_sel_hi:[0,1]
    v_pk_mul_f16 v65, v36, v17 op_sel:[0,0] op_sel_hi:[0,1]
    v_pk_mul_f16 v66, v36, v18 op_sel:[0,0] op_sel_hi:[0,1]
    v_pk_mul_f16 v67, v36, v19 op_sel:[0,0] op_sel_hi:[0,1]
    v_mfma_f32_32x32x16_f16 v[40:55], v[76:79], v[60:63], v[40:55]
    ds_read_b128 v[72:75], v160 offset:480
    v_pk_mul_f16 v56, v36, v20 op_sel:[0,0] op_sel_hi:[0,1]
    v_pk_mul_f16 v57, v36, v21 op_sel:[0,0] op_sel_hi:[0,1]
    v_pk_mul_f16 v58, v36, v22 op_sel:[0,0] op_sel_hi:[0,1]
    v_pk_mul_f16 v59, v36, v23 op_sel:[0,0] op_sel_hi:[0,1]
    ds_read_b32 v148, v39 offset:1536
    s_waitcnt lgkmcnt(4)
    v_mfma_f32_32x32x16_f16 v[40:55], v[80:83], v[64:67], v[40:55]
    ds_read_b128 v[76:79], v160 offset:496
    v_pk_mul_f16 v60, v36, v24 op_sel:[0,0] op_sel_hi:[0,1]
    v_pk_mul_f16 v61, v36, v25 op_sel:[0,0] op_sel_hi:[0,1]
    v_pk_mul_f16 v62, v36, v26 op_sel:[0,0] op_sel_hi:[0,1]
    v_pk_mul_f16 v63, v36, v27 op_sel:[0,0] op_sel_hi:[0,1]
    v_mfma_f32_32x32x16_f16 v[40:55], v[84:87], v[56:59], v[40:55]
    ds_read_b128 v[80:83], v160 offset:512
    v_pk_mul_f16 v64, v36, v28 op_sel:[0,0] op_sel_hi:[0,1]
    v_pk_mul_f16 v65, v36, v16 op_sel:[1,0] op_sel_hi:[1,1]
    v_pk_mul_f16 v66, v36, v17 op_sel:[1,0] op_sel_hi:[1,1]
    v_pk_mul_f16 v67, v36, v18 op_sel:[1,0] op_sel_hi:[1,1]
    s_waitcnt lgkmcnt(4)
    v_mfma_f32_32x32x16_f16 v[40:55], v[4:7], v[60:63], v[40:55]
    ds_read_b128 v[84:87], v160 offset:528
    v_pk_mul_f16 v56, v36, v19 op_sel:[1,0] op_sel_hi:[1,1]
    v_pk_mul_f16 v57, v36, v20 op_sel:[1,0] op_sel_hi:[1,1]
    v_pk_mul_f16 v58, v36, v21 op_sel:[1,0] op_sel_hi:[1,1]
    v_pk_mul_f16 v59, v36, v22 op_sel:[1,0] op_sel_hi:[1,1]
    v_mfma_f32_32x32x16_f16 v[40:55], v[8:11], v[64:67], v[40:55]
    ds_read_b128 v[4:7], v160 offset:544
    v_pk_mul_f16 v60, v36, v23 op_sel:[1,0] op_sel_hi:[1,1]
    v_pk_mul_f16 v61, v36, v24 op_sel:[1,0] op_sel_hi:[1,1]
    v_pk_mul_f16 v62, v36, v25 op_sel:[1,0] op_sel_hi:[1,1]
    v_pk_mul_f16 v63, v36, v26 op_sel:[1,0] op_sel_hi:[1,1]
    s_waitcnt lgkmcnt(3)
    v_mfma_f32_32x32x16_f16 v[40:55], v[72:75], v[56:59], v[40:55]
    ds_read_b128 v[8:11], v160 offset:560
    v_pk_mul_f16 v64, v36, v27 op_sel:[1,0] op_sel_hi:[1,1]
    v_pk_mul_f16 v65, v36, v28 op_sel:[1,0] op_sel_hi:[1,1]
    v_pk_mul_f16 v66, v37, v16 op_sel:[0,0] op_sel_hi:[0,1]
    v_pk_mul_f16 v67, v37, v17 op_sel:[0,0] op_sel_hi:[0,1]
    v_mov_b32 v149, 0
    v_mov_b32 v150, 0
    v_mov_b32 v151, 0
    v_mfma_f32_32x32x16_f16 v[40:55], v[76:79], v[60:63], v[40:55]
    ds_read_b128 v[72:75], v160 offset:576
    v_pk_mul_f16 v56, v37, v18 op_sel:[0,0] op_sel_hi:[0,1]
    v_pk_mul_f16 v57, v37, v19 op_sel:[0,0] op_sel_hi:[0,1]
    v_pk_mul_f16 v58, v37, v20 op_sel:[0,0] op_sel_hi:[0,1]
    v_pk_mul_f16 v59, v37, v21 op_sel:[0,0] op_sel_hi:[0,1]
    v_mfma_f32_32x32x16_bf16 v[116:131], v[144:147], v[148:151], v[116:131]
    s_waitcnt lgkmcnt(3)
    v_mfma_f32_32x32x16_f16 v[40:55], v[80:83], v[64:67], v[40:55]
    ds_read_b128 v[76:79], v160 offset:592
    v_pk_mul_f16 v60, v37, v22 op_sel:[0,0] op_sel_hi:[0,1]
    v_pk_mul_f16 v61, v37, v23 op_sel:[0,0] op_sel_hi:[0,1]
    v_pk_mul_f16 v62, v37, v24 op_sel:[0,0] op_sel_hi:[0,1]
    v_pk_mul_f16 v63, v37, v25 op_sel:[0,0] op_sel_hi:[0,1]
    v_mfma_f32_32x32x16_f16 v[40:55], v[84:87], v[56:59], v[40:55]
    ds_read_b128 v[80:83], v160 offset:608
    v_pk_mul_f16 v64, v37, v26 op_sel:[0,0] op_sel_hi:[0,1]
    v_pk_mul_f16 v65, v37, v27 op_sel:[0,0] op_sel_hi:[0,1]
    v_pk_mul_f16 v66, v37, v28 op_sel:[0,0] op_sel_hi:[0,1]
    v_pk_mul_f16 v67, v37, v16 op_sel:[1,0] op_sel_hi:[1,1]
    s_waitcnt lgkmcnt(3)
    v_mfma_f32_32x32x16_f16 v[40:55], v[4:7], v[60:63], v[40:55]
    ds_read_b128 v[84:87], v160 offset:624
    v_pk_mul_f16 v56, v37, v17 op_sel:[1,0] op_sel_hi:[1,1]
    v_pk_mul_f16 v57, v37, v18 op_sel:[1,0] op_sel_hi:[1,1]
    v_pk_mul_f16 v58, v37, v19 op_sel:[1,0] op_sel_hi:[1,1]
    v_pk_mul_f16 v59, v37, v20 op_sel:[1,0] op_sel_hi:[1,1]
    ds_read_b128 v[102:105], v101 offset:384
    ds_read_b128 v[106:109], v101 offset:400
    ds_read_b128 v[110:113], v101 offset:416
    ds_read_b32 v114, v101 offset:432
    v_mfma_f32_32x32x16_f16 v[40:55], v[8:11], v[64:67], v[40:55]
    ds_read_b128 v[4:7], v160 offset:640
    v_pk_mul_f16 v60, v37, v21 op_sel:[1,0] op_sel_hi:[1,1]
    v_pk_mul_f16 v61, v37, v22 op_sel:[1,0] op_sel_hi:[1,1]
    v_pk_mul_f16 v62, v37, v23 op_sel:[1,0] op_sel_hi:[1,1]
    v_pk_mul_f16 v63, v37, v24 op_sel:[1,0] op_sel_hi:[1,1]
    s_waitcnt lgkmcnt(7)
    v_mfma_f32_32x32x16_f16 v[40:55], v[72:75], v[56:59], v[40:55]
    ds_read_b128 v[8:11], v160 offset:656
    v_pk_mul_f16 v64, v37, v25 op_sel:[1,0] op_sel_hi:[1,1]
    v_pk_mul_f16 v65, v37, v26 op_sel:[1,0] op_sel_hi:[1,1]
    v_pk_mul_f16 v66, v37, v27 op_sel:[1,0] op_sel_hi:[1,1]
    v_pk_mul_f16 v67, v37, v28 op_sel:[1,0] op_sel_hi:[1,1]
    v_mfma_f32_32x32x16_f16 v[40:55], v[76:79], v[60:63], v[40:55]
    ds_read_b128 v[72:75], v160 offset:672
    v_pk_mul_f16 v56, v38, v16 op_sel:[0,0] op_sel_hi:[0,1]
    v_pk_mul_f16 v57, v38, v17 op_sel:[0,0] op_sel_hi:[0,1]
    v_pk_mul_f16 v58, v38, v18 op_sel:[0,0] op_sel_hi:[0,1]
    v_pk_mul_f16 v59, v38, v19 op_sel:[0,0] op_sel_hi:[0,1]
    s_waitcnt lgkmcnt(7)
    v_mfma_f32_32x32x16_f16 v[40:55], v[80:83], v[64:67], v[40:55]
    v_pk_mul_f16 v60, v38, v20 op_sel:[0,0] op_sel_hi:[0,1]
    v_pk_mul_f16 v61, v38, v21 op_sel:[0,0] op_sel_hi:[0,1]
    v_pk_mul_f16 v62, v38, v22 op_sel:[0,0] op_sel_hi:[0,1]
    v_pk_mul_f16 v63, v38, v23 op_sel:[0,0] op_sel_hi:[0,1]
    v_mfma_f32_32x32x16_f16 v[40:55], v[84:87], v[56:59], v[40:55]
    v_pk_mul_f16 v64, v38, v24 op_sel:[0,0] op_sel_hi:[0,1]
    v_pk_mul_f16 v65, v38, v25 op_sel:[0,0] op_sel_hi:[0,1]
    v_pk_mul_f16 v66, v38, v26 op_sel:[0,0] op_sel_hi:[0,1]
    v_pk_mul_f16 v67, v38, v27 op_sel:[0,0] op_sel_hi:[0,1]
    s_waitcnt lgkmcnt(1)
    v_mfma_f32_32x32x16_f16 v[40:55], v[4:7], v[60:63], v[40:55]
    v_pk_mul_f16 v68, v38, v28 op_sel:[0,0] op_sel_hi:[0,1]
    v_mfma_f32_32x32x16_f16 v[40:55], v[8:11], v[64:67], v[40:55]
    s_waitcnt lgkmcnt(0)
    v_mfma_f32_32x32x16_f16 v[40:55], v[72:75], v[68:71], v[40:55]
    ds_read_b32 v166, v165 offset:8
    s_waitcnt lgkmcnt(0)
    v_readfirstlane_b32 s69, v166
    s_nop 0
    s_cmp_ge_u32 s69, 6
    s_cbranch_scc1 L_ok21
    s_mov_b32 s70, 0x100000
L_sp21:
    s_sleep 1
    ds_read_b32 v166, v165 offset:8
    s_sub_u32 s70, s70, 1
    s_cbranch_scc1 L_ok21
    s_waitcnt lgkmcnt(0)
    v_readfirstlane_b32 s69, v166
    s_nop 0
    s_cmp_ge_u32 s69, 6
    s_cbranch_scc0 L_sp21
L_ok21:
    ds_read_b128 v[72:75], v161 offset:0
    ds_read_b128 v[76:79], v161 offset:16
    ds_read_b128 v[80:83], v161 offset:32
    ds_read_b128 v[84:87], v161 offset:48
    ds_read_b128 v[4:7], v161 offset:64
    v_mov_b32 v2, 0x05040100
    v_mov_b32 v3, 0x07060302
    v_cndmask_b32 v2, v2, v3, s[74:75]
    v_perm_b32 v32, v17, v16, v2
    v_perm_b32 v33, v19, v18, v2
    v_perm_b32 v34, v21, v20, v2
    v_perm_b32 v35, v23, v22, v2
    v_perm_b32 v36, v25, v24, v2
    v_perm_b32 v37, v27, v26, v2
    v_perm_b32 v38, v29, v28, v2
    v_pk_mul_f16 v56, v152, v16 op_sel:[0,0] op_sel_hi:[0,1]
    v_pk_mul_f16 v57, v32, v17 op_sel:[0,0] op_sel_hi:[0,1]
    v_pk_mul_f16 v58, v32, v18 op_sel:[0,0] op_sel_hi:[0,1]
    v_pk_mul_f16 v59, v32, v19 op_sel:[0,0] op_sel_hi:[0,1]
    v_pk_mul_f16 v60, v32, v20 op_sel:[0,0] op_sel_hi:[0,1]
    v_pk_mul_f16 v61, v32, v21 op_sel:[0,0] op_sel_hi:[0,1]
    v_pk_mul_f16 v62, v32, v22 op_sel:[0,0] op_sel_hi:[0,1]
    v_pk_mul_f16 v63, v32, v23 op_sel:[0,0] op_sel_hi:[0,1]
    s_waitcnt lgkmcnt(3)
    v_mfma_f32_32x32x16_f16 v[132:147], v[72:75], v[56:59], 0
    ds_read_b128 v[8:11], v161 offset:80
    v_pk_mul_f16 v64, v32, v24 op_sel:[0,0] op_sel_hi:[0,1]
    v_pk_mul_f16 v65, v32, v25 op_sel:[0,0] op_sel_hi:[0,1]
    v_pk_mul_f16 v66, v32, v26 op_sel:[0,0] op_sel_hi:[0,1]
    v_pk_mul_f16 v67, v32, v27 op_sel:[0,0] op_sel_hi:[0,1]
    v_mfma_f32_32x32x16_f16 v[132:147], v[76:79], v[60:63], v[132:147]
    ds_read_b128 v[72:75], v161 offset:96
    v_pk_mul_f16 v56, v32, v28 op_sel:[0,0] op_sel_hi:[0,1]
    v_pk_mul_f16 v57, v152, v17 op_sel:[1,0] op_sel_hi:[1,1]
    v_pk_mul_f16 v58, v32, v18 op_sel:[1,0] op_sel_hi:[1,1]
    v_pk_mul_f16 v59, v32, v19 op_sel:[1,0] op_sel_hi:[1,1]
    v_ldexp_f32 v40, v40, v102
    s_waitcnt lgkmcnt(3)
    v_mfma_f32_32x32x16_f16 v[132:147], v[80:83], v[64:67], v[132:147]
    ds_read_b128 v[76:79], v161 offset:112
    v_pk_mul_f16 v60, v32, v20 op_sel:[1,0] op_sel_hi:[1,1]
    v_pk_mul_f16 v61, v32, v21 op_sel:[1,0] op_sel_hi:[1,1]
    v_pk_mul_f16 v62, v32, v22 op_sel:[1,0] op_sel_hi:[1,1]
    v_pk_mul_f16 v63, v32, v23 op_sel:[1,0] op_sel_hi:[1,1]
    s_setprio 2
    v_ldexp_f32 v41, v41, v103
    v_mfma_f32_32x32x16_f16 v[132:147], v[84:87], v[56:59], v[132:147]
    ds_read_b128 v[80:83], v161 offset:128
    v_pk_mul_f16 v64, v32, v24 op_sel:[1,0] op_sel_hi:[1,1]
    v_pk_mul_f16 v65, v32, v25 op_sel:[1,0] op_sel_hi:[1,1]
    v_pk_mul_f16 v66, v32, v26 op_sel:[1,0] op_sel_hi:[1,1]
    v_pk_mul_f16 v67, v32, v27 op_sel:[1,0] op_sel_hi:[1,1]
    v_ldexp_f32 v42, v42, v104
    s_waitcnt lgkmcnt(3)
    v_mfma_f32_32x32x16_f16 v[132:147], v[4:7], v[60:63], v[132:147]
    ds_read_b128 v[84:87], v161 offset:144
    v_pk_mul_f16 v56, v32, v28 op_sel:[1,0] op_sel_hi:[1,1]
    v_pk_mul_f16 v57, v153, v18 op_sel:[0,0] op_sel_hi:[0,1]
    v_pk_mul_f16 v58, v33, v19 op_sel:[0,0] op_sel_hi:[0,1]
    v_pk_mul_f16 v59, v33, v20 op_sel:[0,0] op_sel_hi:[0,1]
    v_ldexp_f32 v43, v43, v105
    v_ldexp_f32 v44, v44, v106
    v_mfma_f32_32x32x16_f16 v[132:147], v[8:11], v[64:67], v[132:147]
    ds_read_b128 v[4:7], v161 offset:160
    v_pk_mul_f16 v60, v33, v21 op_sel:[0,0] op_sel_hi:[0,1]
    v_pk_mul_f16 v61, v33, v22 op_sel:[0,0] op_sel_hi:[0,1]
    v_pk_mul_f16 v62, v33, v23 op_sel:[0,0] op_sel_hi:[0,1]
    v_pk_mul_f16 v63, v33, v24 op_sel:[0,0] op_sel_hi:[0,1]
    v_ldexp_f32 v45, v45, v107
    s_waitcnt lgkmcnt(3)
    v_mfma_f32_32x32x16_f16 v[132:147], v[72:75], v[56:59], v[132:147]
    ds_read_b128 v[8:11], v161 offset:176
    v_pk_mul_f16 v64, v33, v25 op_sel:[0,0] op_sel_hi:[0,1]
    v_pk_mul_f16 v65, v33, v26 op_sel:[0,0] op_sel_hi:[0,1]
    v_pk_mul_f16 v66, v33, v27 op_sel:[0,0] op_sel_hi:[0,1]
    v_pk_mul_f16 v67, v33, v28 op_sel:[0,0] op_sel_hi:[0,1]
    v_ldexp_f32 v46, v46, v108
    v_mfma_f32_32x32x16_f16 v[132:147], v[76:79], v[60:63], v[132:147]
    ds_read_b128 v[72:75], v161 offset:192
    v_pk_mul_f16 v56, v153, v19 op_sel:[1,0] op_sel_hi:[1,1]
    v_pk_mul_f16 v57, v33, v20 op_sel:[1,0] op_sel_hi:[1,1]
    v_pk_mul_f16 v58, v33, v21 op_sel:[1,0] op_sel_hi:[1,1]
    v_pk_mul_f16 v59, v33, v22 op_sel:[1,0] op_sel_hi:[1,1]
    v_ldexp_f32 v47, v47, v109
    s_waitcnt lgkmcnt(3)
    v_mfma_f32_32x32x16_f16 v[132:147], v[80:83], v[64:67], v[132:147]
    ds_read_b128 v[76:79], v161 offset:208
    v_pk_mul_f16 v60, v33, v23 op_sel:[1,0] op_sel_hi:[1,1]
    v_pk_mul_f16 v61, v33, v24 op_sel:[1,0] op_sel_hi:[1,1]
    v_pk_mul_f16 v62, v33, v25 op_sel:[1,0] op_sel_hi:[1,1]
    v_pk_mul_f16 v63, v33, v26 op_sel:[1,0] op_sel_hi:[1,1]
    v_ldexp_f32 v48, v48, v110
    v_ldexp_f32 v49, v49, v111
    v_mfma_f32_32x32x16_f16 v[132:147], v[84:87], v[56:59], v[132:147]
    ds_read_b128 v[80:83], v161 offset:224
    v_pk_mul_f16 v64, v33, v27 op_sel:[1,0] op_sel_hi:[1,1]
    v_pk_mul_f16 v65, v33, v28 op_sel:[1,0] op_sel_hi:[1,1]
    v_pk_mul_f16 v66, v154, v20 op_sel:[0,0] op_sel_hi:[0,1]
    v_pk_mul_f16 v67, v34, v21 op_sel:[0,0] op_sel_hi:[0,1]
    v_ldexp_f32 v50, v50, v112
    s_waitcnt lgkmcnt(3)
    v_mfma_f32_32x32x16_f16 v[132:147], v[4:7], v[60:63], v[132:147]
    ds_read_b128 v[84:87], v161 offset:240
    v_pk_mul_f16 v56, v34, v22 op_sel:[0,0] op_sel_hi:[0,1]
    v_pk_mul_f16 v57, v34, v23 op_sel:[0,0] op_sel_hi:[0,1]
    v_pk_mul_f16 v58, v34, v24 op_sel:[0,0] op_sel_hi:[0,1]
    v_pk_mul_f16 v59, v34, v25 op_sel:[0,0] op_sel_hi:[0,1]
    v_ldexp_f32 v51, v51, v113
    v_mfma_f32_32x32x16_f16 v[132:147], v[8:11], v[64:67], v[132:147]
    ds_read_b128 v[4:7], v161 offset:256
    v_pk_mul_f16 v60, v34, v26 op_sel:[0,0] op_sel_hi:[0,1]
    v_pk_mul_f16 v61, v34, v27 op_sel:[0,0] op_sel_hi:[0,1]
    v_pk_mul_f16 v62, v34, v28 op_sel:[0,0] op_sel_hi:[0,1]
    v_pk_mul_f16 v63, v154, v21 op_sel:[1,0] op_sel_hi:[1,1]
    v_ldexp_f32 v52, v52, v114
    s_waitcnt lgkmcnt(3)
    v_mfma_f32_32x32x16_f16 v[132:147], v[72:75], v[56:59], v[132:147]
    ds_read_b128 v[8:11], v161 offset:272
    v_pk_mul_f16 v64, v34, v22 op_sel:[1,0] op_sel_hi:[1,1]
    v_pk_mul_f16 v65, v34, v23 op_sel:[1,0] op_sel_hi:[1,1]
    v_pk_mul_f16 v66, v34, v24 op_sel:[1,0] op_sel_hi:[1,1]
    v_pk_mul_f16 v67, v34, v25 op_sel:[1,0] op_sel_hi:[1,1]
    v_mul_f32 v148, v40, v116
    v_fmac_f32 v148, v41, v117
    v_mfma_f32_32x32x16_f16 v[132:147], v[76:79], v[60:63], v[132:147]
    ds_read_b128 v[72:75], v161 offset:288
    v_pk_mul_f16 v56, v34, v26 op_sel:[1,0] op_sel_hi:[1,1]
    v_pk_mul_f16 v57, v34, v27 op_sel:[1,0] op_sel_hi:[1,1]
    v_pk_mul_f16 v58, v34, v28 op_sel:[1,0] op_sel_hi:[1,1]
    v_pk_mul_f16 v59, v155, v22 op_sel:[0,0] op_sel_hi:[0,1]
    v_fmac_f32 v148, v42, v118
    s_waitcnt lgkmcnt(3)
    v_mfma_f32_32x32x16_f16 v[132:147], v[80:83], v[64:67], v[132:147]
    ds_read_b128 v[76:79], v161 offset:304
    v_pk_mul_f16 v60, v35, v23 op_sel:[0,0] op_sel_hi:[0,1]
    v_pk_mul_f16 v61, v35, v24 op_sel:[0,0] op_sel_hi:[0,1]
    v_pk_mul_f16 v62, v35, v25 op_sel:[0,0] op_sel_hi:[0,1]
    v_pk_mul_f16 v63, v35, v26 op_sel:[0,0] op_sel_hi:[0,1]
    v_fmac_f32 v148, v43, v119
    ds_read_b128 v[88:91], v101 offset:512
    ds_read_b128 v[92:95], v101 offset:528
    ds_read_b128 v[96:99], v101 offset:544
    ds_read_b32 v100, v101 offset:560
    v_mfma_f32_32x32x16_f16 v[132:147], v[84:87], v[56:59], v[132:147]
    ds_read_b128 v[80:83], v161 offset:320
    v_pk_mul_f16 v64, v35, v27 op_sel:[0,0] op_sel_hi:[0,1]
    v_pk_mul_f16 v65, v35, v28 op_sel:[0,0] op_sel_hi:[0,1]
    v_pk_mul_f16 v66, v155, v23 op_sel:[1,0] op_sel_hi:[1,1]
    v_pk_mul_f16 v67, v35, v24 op_sel:[1,0] op_sel_hi:[1,1]
    v_fmac_f32 v148, v44, v120
    s_waitcnt lgkmcnt(7)
    v_mfma_f32_32x32x16_f16 v[132:147], v[4:7], v[60:63], v[132:147]
    ds_read_b128 v[84:87], v161 offset:336
    v_pk_mul_f16 v56, v35, v25 op_sel:[1,0] op_sel_hi:[1,1]
    v_pk_mul_f16 v57, v35, v26 op_sel:[1,0] op_sel_hi:[1,1]
    v_pk_mul_f16 v58, v35, v27 op_sel:[1,0] op_sel_hi:[1,1]
    v_pk_mul_f16 v59, v35, v28 op_sel:[1,0] op_sel_hi:[1,1]
    v_fmac_f32 v148, v45, v121
    v_fmac_f32 v148, v46, v122
    v_mfma_f32_32x32x16_f16 v[132:147], v[8:11], v[64:67], v[132:147]
    ds_read_b128 v[4:7], v161 offset:352
    v_pk_mul_f16 v60, v156, v24 op_sel:[0,0] op_sel_hi:[0,1]
    v_pk_mul_f16 v61, v36, v25 op_sel:[0,0] op_sel_hi:[0,1]
    v_pk_mul_f16 v62, v36, v26 op_sel:[0,0] op_sel_hi:[0,1]
    v_pk_mul_f16 v63, v36, v27 op_sel:[0,0] op_sel_hi:[0,1]
    v_fmac_f32 v148, v47, v123
    s_waitcnt lgkmcnt(7)
    v_mfma_f32_32x32x16_f16 v[132:147], v[72:75], v[56:59], v[132:147]
    v_pk_mul_f16 v64, v36, v28 op_sel:[0,0] op_sel_hi:[0,1]
    v_pk_mul_f16 v65, v156, v25 op_sel:[1,0] op_sel_hi:[1,1]
    v_pk_mul_f16 v66, v36, v26 op_sel:[1,0] op_sel_hi:[1,1]
    v_pk_mul_f16 v67, v36, v27 op_sel:[1,0] op_sel_hi:[1,1]
    v_fmac_f32 v148, v48, v124
    v_fmac_f32 v148, v49, v125
    v_mfma_f32_32x32x16_f16 v[132:147], v[76:79], v[60:63], v[132:147]
    v_pk_mul_f16 v56, v36, v28 op_sel:[1,0] op_sel_hi:[1,1]
    v_pk_mul_f16 v57, v157, v26 op_sel:[0,0] op_sel_hi:[0,1]
    v_pk_mul_f16 v58, v37, v27 op_sel:[0,0] op_sel_hi:[0,1]
    v_pk_mul_f16 v59, v37, v28 op_sel:[0,0] op_sel_hi:[0,1]
    v_fmac_f32 v148, v50, v126
    v_fmac_f32 v148, v51, v127
    s_waitcnt lgkmcnt(1)
    v_mfma_f32_32x32x16_f16 v[132:147], v[80:83], v[64:67], v[132:147]
    v_pk_mul_f16 v68, v157, v27 op_sel:[1,0] op_sel_hi:[1,1]
    v_pk_mul_f16 v69, v37, v28 op_sel:[1,0] op_sel_hi:[1,1]
    v_pk_mul_f16 v70, v158, v28 op_sel:[0,0] op_sel_hi:[0,1]
    v_fmac_f32 v148, v52, v128
    v_mfma_f32_32x32x16_f16 v[132:147], v[84:87], v[56:59], v[132:147]
    s_waitcnt lgkmcnt(0)
    v_mfma_f32_32x32x16_f16 v[132:147], v[4:7], v[68:71], v[132:147]
    ds_read_b32 v166, v165 offset:8
    s_waitcnt lgkmcnt(0)
    v_readfirstlane_b32 s69, v166
    s_nop 0
    s_cmp_ge_u32 s69, 7
    s_cbranch_scc1 L_ok22
    s_mov_b32 s70, 0x100000
L_sp22:
    s_sleep 1
    ds_read_b32 v166, v165 offset:8
    s_sub_u32 s70, s70, 1
    s_cbranch_scc1 L_ok22
    s_waitcnt lgkmcnt(0)
    v_readfirstlane_b32 s69, v166
    s_nop 0
    s_cmp_ge_u32 s69, 7
    s_cbranch_scc0 L_sp22
L_ok22:
    v_bfe_u32 v7, v1, 4, 1
    v_and_b32 v8, 15, v1
    v_lshl_add_u32 v7, v8, 4, v7
    v_lshlrev_b32 v7, 2, v7
    s_lshl_b32 s69, s68, 3
    s_add_u32 s69, s69, 162048
    v_add_u32 v7, s69, v7
    v_and_b32 v8, 44, v1
    v_cmp_eq_u32 vcc, 0, v8
    v_mov_b32 v8, 0x30000
    s_nop 0
    v_cndmask_b32 v7, v8, v7, vcc
    ds_read_b32 v8, v7
    v_lshl_add_u32 v88, v14, 1, v88
    v_lshl_add_u32 v89, v14, 1, v89
    v_lshl_add_u32 v90, v14, 1, v90
    v_lshl_add_u32 v91, v14, 1, v91
    v_lshl_add_u32 v92, v14, 1, v92
    v_lshl_add_u32 v93, v14, 1, v93
    v_lshl_add_u32 v94, v14, 1, v94
    v_lshl_add_u32 v95, v14, 1, v95
    v_lshl_add_u32 v96, v14, 1, v96
    v_lshl_add_u32 v97, v14, 1, v97
    v_lshl_add_u32 v98, v14, 1, v98
    v_lshl_add_u32 v99, v14, 1, v99
    v_lshl_add_u32 v100, v14, 1, v100
    v_ldexp_f32 v132, v132, v88
    v_ldexp_f32 v133, v133, v89
    v_ldexp_f32 v134, v134, v90
    v_ldexp_f32 v135, v135, v91
    v_ldexp_f32 v136, v136, v92
    v_ldexp_f32 v137, v137, v93
    v_ldexp_f32 v138, v138, v94
    v_ldexp_f32 v139, v139, v95
    v_ldexp_f32 v140, v140, v96
    v_ldexp_f32 v141, v141, v97
    v_ldexp_f32 v142, v142, v98
    v_ldexp_f32 v143, v143, v99
    v_ldexp_f32 v144, v144, v100
    v_fmac_f32 v148, v40, v132
    v_fmac_f32 v148, v41, v133
    v_fmac_f32 v148, v42, v134
    v_fmac_f32 v148, v43, v135
    v_fmac_f32 v148, v44, v136
    v_fmac_f32 v148, v45, v137
    v_fmac_f32 v148, v46, v138
    v_fmac_f32 v148, v47, v139
    v_fmac_f32 v148, v48, v140
    v_fmac_f32 v148, v49, v141
    v_fmac_f32 v148, v50, v142
    v_fmac_f32 v148, v51, v143
    v_fmac_f32 v148, v52, v144
    v_ldexp_f32 v148, v148, v13
    v_add_f32 v15, v15, v148
    s_waitcnt lgkmcnt(0)
    v_add_f32 v15, v15, v8
    s_nop 1
    v_add_f32_dpp v15, v15, v15 row_ror:8 row_mask:0xf bank_mask:0xf
    s_nop 1
    v_add_f32_dpp v15, v15, v15 row_ror:4 row_mask:0xf bank_mask:0xf
    s_nop 1
    v_add_f32_dpp v15, v15, v15 row_ror:2 row_mask:0xf bank_mask:0xf
    s_nop 1
    v_add_f32_dpp v15, v15, v15 row_ror:1 row_mask:0xf bank_mask:0xf
    v_mov_b32 v7, v15
    s_nop 1
    v_permlane32_swap_b32 v15, v7
    v_add_f32 v15, v15, v7
    v_cvt_pk_bf16_f32 v15, v15, v15
    v_lshrrev_b32 v7, 3, v1
    s_lshl_b32 s69, s2, 5
    s_lshl_b32 s70, s68, 2
    s_add_u32 s69, s69, s70
    s_mov_b64 exec, 0x10001
    buffer_store_short v15, v7, s[56:59], s69 offen
    s_endpgm
L_loader:
    s_movk_i32 s69, 4682
    v_add_u32 v2, 0, v1
    v_mul_u32_u24 v3, s69, v2
    v_lshrrev_b32 v3, 16, v3
    v_mul_u32_u24 v4, 608, v3
    v_lshl_add_u32 v32, v2, 4, v4
    v_add_u32 v2, 64, v1
    v_mul_u32_u24 v3, s69, v2
    v_lshrrev_b32 v3, 16, v3
    v_mul_u32_u24 v4, 608, v3
    v_lshl_add_u32 v33, v2, 4, v4
    v_add_u32 v2, 128, v1
    v_mul_u32_u24 v3, s69, v2
    v_lshrrev_b32 v3, 16, v3
    v_mul_u32_u24 v4, 608, v3
    v_lshl_add_u32 v34, v2, 4, v4
    v_add_u32 v2, 192, v1
    v_mul_u32_u24 v3, s69, v2
    v_lshrrev_b32 v3, 16, v3
    v_mul_u32_u24 v4, 608, v3
    v_lshl_add_u32 v35, v2, 4, v4
    v_add_u32 v2, 256, v1
    v_mul_u32_u24 v3, s69, v2
    v_lshrrev_b32 v3, 16, v3
    v_mul_u32_u24 v4, 608, v3
    v_lshl_add_u32 v36, v2, 4, v4
    v_add_u32 v2, 320, v1
    v_mul_u32_u24 v3, s69, v2
    v_lshrrev_b32 v3, 16, v3
    v_mul_u32_u24 v4, 608, v3
    v_lshl_add_u32 v37, v2, 4, v4
    v_add_u32 v2, 384, v1
    v_mul_u32_u24 v3, s69, v2
    v_lshrrev_b32 v3, 16, v3
    v_mul_u32_u24 v4, 608, v3
    v_lshl_add_u32 v38, v2, 4, v4
    v_lshlrev_b32 v19, 2, v1
    v_mov_b32 v20, 163712
    v_and_b32 v21, 28, v19
    v_add_u32 v21, 163744, v21
    s_mul_i32 s90, s83, 26624
    s_lshl_b32 s69, s89, 5
    s_add_u32 s90, s90, s69
    s_add_u32 s72, s69, 346112
    s_waitcnt lgkmcnt(0)
    s_mov_b32 m0, 121600
    s_nop 0
    buffer_load_dwordx4 v32, s[40:43], s90 offen lds
    s_mov_b32 m0, 122624
    s_nop 0
    buffer_load_dwordx4 v33, s[40:43], s90 offen lds
    s_mov_b32 m0, 123648
    s_nop 0
    buffer_load_dwordx4 v34, s[40:43], s90 offen lds
    s_mov_b32 m0, 124672
    s_nop 0
    buffer_load_dwordx4 v35, s[40:43], s90 offen lds
    s_mov_b32 m0, 125696
    s_nop 0
    buffer_load_dwordx4 v36, s[40:43], s90 offen lds
    s_mov_b32 m0, 126720
    s_nop 0
    buffer_load_dwordx4 v37, s[40:43], s90 offen lds
    s_mov_b32 m0, 127744
    s_nop 0
    buffer_load_dwordx4 v38, s[40:43], s90 offen lds
    s_add_u32 s90, s90, 26624
    s_cmp_eq_u32 s90, s72
    s_cselect_b32 s70, 346112, 0
    s_sub_u32 s90, s90, s70
    s_mov_b32 m0, 128768
    s_nop 0
    buffer_load_dwordx4 v32, s[40:43], s90 offen lds
    s_mov_b32 m0, 129792
    s_nop 0
    buffer_load_dwordx4 v33, s[40:43], s90 offen lds
    s_mov_b32 m0, 130816
    s_nop 0
    buffer_load_dwordx4 v34, s[40:43], s90 offen lds
    s_mov_b32 m0, 131840
    s_nop 0
    buffer_load_dwordx4 v35, s[40:43], s90 offen lds
    s_mov_b32 m0, 132864
    s_nop 0
    buffer_load_dwordx4 v36, s[40:43], s90 offen lds
    s_mov_b32 m0, 133888
    s_nop 0
    buffer_load_dwordx4 v37, s[40:43], s90 offen lds
    s_mov_b32 m0, 134912
    s_nop 0
    buffer_load_dwordx4 v38, s[40:43], s90 offen lds
    s_add_u32 s90, s90, 26624
    s_cmp_eq_u32 s90, s72
    s_cselect_b32 s70, 346112, 0
    s_sub_u32 s90, s90, s70
    s_mov_b32 m0, 135936
    s_nop 0
    buffer_load_dwordx4 v32, s[40:43], s90 offen lds
    s_mov_b32 m0, 136960
    s_nop 0
    buffer_load_dwordx4 v33, s[40:43], s90 offen lds
    s_mov_b32 m0, 137984
    s_nop 0
    buffer_load_dwordx4 v34, s[40:43], s90 offen lds
    s_mov_b32 m0, 139008
    s_nop 0
    buffer_load_dwordx4 v35, s[40:43], s90 offen lds
    s_mov_b32 m0, 140032
    s_nop 0
    buffer_load_dwordx4 v36, s[40:43], s90 offen lds
    s_mov_b32 m0, 141056
    s_nop 0
    buffer_load_dwordx4 v37, s[40:43], s90 offen lds
    s_mov_b32 m0, 142080
    s_nop 0
    buffer_load_dwordx4 v38, s[40:43], s90 offen lds
    s_add_u32 s90, s90, 26624
    s_cmp_eq_u32 s90, s72
    s_cselect_b32 s70, 346112, 0
    s_sub_u32 s90, s90, s70
    s_mov_b32 m0, 0
    s_nop 0
    buffer_load_dwordx4 v32, s[40:43], s90 offen lds
    s_mov_b32 m0, 1024
    s_nop 0
    buffer_load_dwordx4 v33, s[40:43], s90 offen lds
    s_mov_b32 m0, 2048
    s_nop 0
    buffer_load_dwordx4 v34, s[40:43], s90 offen lds
    s_mov_b32 m0, 3072
    s_nop 0
    buffer_load_dwordx4 v35, s[40:43], s90 offen lds
    s_mov_b32 m0, 4096
    s_nop 0
    buffer_load_dwordx4 v36, s[40:43], s90 offen lds
    s_mov_b32 m0, 5120
    s_nop 0
    buffer_load_dwordx4 v37, s[40:43], s90 offen lds
    s_mov_b32 m0, 6144
    s_nop 0
    buffer_load_dwordx4 v38, s[40:43], s90 offen lds
    s_add_u32 s90, s90, 26624
    s_cmp_eq_u32 s90, s72
    s_cselect_b32 s70, 346112, 0
    s_sub_u32 s90, s90, s70
    s_mov_b32 m0, 7168
    s_nop 0
    buffer_load_dwordx4 v32, s[40:43], s90 offen lds
    s_mov_b32 m0, 8192
    s_nop 0
    buffer_load_dwordx4 v33, s[40:43], s90 offen lds
    s_mov_b32 m0, 9216
    s_nop 0
    buffer_load_dwordx4 v34, s[40:43], s90 offen lds
    s_mov_b32 m0, 10240
    s_nop 0
    buffer_load_dwordx4 v35, s[40:43], s90 offen lds
    s_mov_b32 m0, 11264
    s_nop 0
    buffer_load_dwordx4 v36, s[40:43], s90 offen lds
    s_mov_b32 m0, 12288
    s_nop 0
    buffer_load_dwordx4 v37, s[40:43], s90 offen lds
    s_mov_b32 m0, 13312
    s_nop 0
    buffer_load_dwordx4 v38, s[40:43], s90 offen lds
    s_add_u32 s90, s90, 26624
    s_cmp_eq_u32 s90, s72
    s_cselect_b32 s70, 346112, 0
    s_sub_u32 s90, s90, s70
    s_mov_b32 m0, 14336
    s_nop 0
    buffer_load_dwordx4 v32, s[40:43], s90 offen lds
    s_mov_b32 m0, 15360
    s_nop 0
    buffer_load_dwordx4 v33, s[40:43], s90 offen lds
    s_mov_b32 m0, 16384
    s_nop 0
    buffer_load_dwordx4 v34, s[40:43], s90 offen lds
    s_mov_b32 m0, 17408
    s_nop 0
    buffer_load_dwordx4 v35, s[40:43], s90 offen lds
    s_mov_b32 m0, 18432
    s_nop 0
    buffer_load_dwordx4 v36, s[40:43], s90 offen lds
    s_mov_b32 m0, 19456
    s_nop 0
    buffer_load_dwordx4 v37, s[40:43], s90 offen lds
    s_mov_b32 m0, 20480
    s_nop 0
    buffer_load_dwordx4 v38, s[40:43], s90 offen lds
    s_add_u32 s90, s90, 26624
    s_cmp_eq_u32 s90, s72
    s_cselect_b32 s70, 346112, 0
    s_sub_u32 s90, s90, s70
    s_mov_b32 m0, 21504
    s_nop 0
    buffer_load_dwordx4 v32, s[40:43], s90 offen lds
    s_mov_b32 m0, 22528
    s_nop 0
    buffer_load_dwordx4 v33, s[40:43], s90 offen lds
    s_mov_b32 m0, 23552
    s_nop 0
    buffer_load_dwordx4 v34, s[40:43], s90 offen lds
    s_mov_b32 m0, 24576
    s_nop 0
    buffer_load_dwordx4 v35, s[40:43], s90 offen lds
    s_mov_b32 m0, 25600
    s_nop 0
    buffer_load_dwordx4 v36, s[40:43], s90 offen lds
    s_mov_b32 m0, 26624
    s_nop 0
    buffer_load_dwordx4 v37, s[40:43], s90 offen lds
    s_mov_b32 m0, 27648
    s_nop 0
    buffer_load_dwordx4 v38, s[40:43], s90 offen lds
    s_add_u32 s90, s90, 26624
    s_cmp_eq_u32 s90, s72
    s_cselect_b32 s70, 346112, 0
    s_sub_u32 s90, s90, s70
    s_mov_b32 m0, 28672
    s_nop 0
    buffer_load_dwordx4 v32, s[40:43], s90 offen lds
    s_mov_b32 m0, 29696
    s_nop 0
    buffer_load_dwordx4 v33, s[40:43], s90 offen lds
    s_mov_b32 m0, 30720
    s_nop 0
    buffer_load_dwordx4 v34, s[40:43], s90 offen lds
    s_mov_b32 m0, 31744
    s_nop 0
    buffer_load_dwordx4 v35, s[40:43], s90 offen lds
    s_mov_b32 m0, 32768
    s_nop 0
    buffer_load_dwordx4 v36, s[40:43], s90 offen lds
    s_mov_b32 m0, 33792
    s_nop 0
    buffer_load_dwordx4 v37, s[40:43], s90 offen lds
    s_mov_b32 m0, 34816
    s_nop 0
    buffer_load_dwordx4 v38, s[40:43], s90 offen lds
    s_add_u32 s90, s90, 26624
    s_cmp_eq_u32 s90, s72
    s_cselect_b32 s70, 346112, 0
    s_sub_u32 s90, s90, s70
    s_mov_b32 m0, 35840
    s_nop 0
    buffer_load_dwordx4 v32, s[40:43], s90 offen lds
    s_mov_b32 m0, 36864
    s_nop 0
    buffer_load_dwordx4 v33, s[40:43], s90 offen lds
    s_mov_b32 m0, 37888
    s_nop 0
    buffer_load_dwordx4 v34, s[40:43], s90 offen lds
    s_mov_b32 m0, 38912
    s_nop 0
    buffer_load_dwordx4 v35, s[40:43], s90 offen lds
    s_mov_b32 m0, 39936
    s_nop 0
    buffer_load_dwordx4 v36, s[40:43], s90 offen lds
    s_mov_b32 m0, 40960
    s_nop 0
    buffer_load_dwordx4 v37, s[40:43], s90 offen lds
    s_mov_b32 m0, 41984
    s_nop 0
    buffer_load_dwordx4 v38, s[40:43], s90 offen lds
    s_add_u32 s90, s90, 26624
    s_cmp_eq_u32 s90, s72
    s_cselect_b32 s70, 346112, 0
    s_sub_u32 s90, s90, s70
    s_mov_b32 m0, 43008
    s_nop 0
    buffer_load_dwordx4 v32, s[40:43], s90 offen lds
    s_mov_b32 m0, 44032
    s_nop 0
    buffer_load_dwordx4 v33, s[40:43], s90 offen lds
    s_mov_b32 m0, 45056
    s_nop 0
    buffer_load_dwordx4 v34, s[40:43], s90 offen lds
    s_mov_b32 m0, 46080
    s_nop 0
    buffer_load_dwordx4 v35, s[40:43], s90 offen lds
    s_mov_b32 m0, 47104
    s_nop 0
    buffer_load_dwordx4 v36, s[40:43], s90 offen lds
    s_mov_b32 m0, 48128
    s_nop 0
    buffer_load_dwordx4 v37, s[40:43], s90 offen lds
    s_mov_b32 m0, 49152
    s_nop 0
    buffer_load_dwordx4 v38, s[40:43], s90 offen lds
    s_add_u32 s90, s90, 26624
    s_cmp_eq_u32 s90, s72
    s_cselect_b32 s70, 346112, 0
    s_sub_u32 s90, s90, s70
    s_waitcnt vmcnt(56)
    v_mov_b32 v23, 3
    ds_write_b32 v20, v23 offset:0
    s_mov_b32 m0, 50176
    s_nop 0
    buffer_load_dwordx4 v32, s[40:43], s90 offen lds
    s_mov_b32 m0, 51200
    s_nop 0
    buffer_load_dwordx4 v33, s[40:43], s90 offen lds
    s_mov_b32 m0, 52224
    s_nop 0
    buffer_load_dwordx4 v34, s[40:43], s90 offen lds
    s_mov_b32 m0, 53248
    s_nop 0
    buffer_load_dwordx4 v35, s[40:43], s90 offen lds
    s_mov_b32 m0, 54272
    s_nop 0
    buffer_load_dwordx4 v36, s[40:43], s90 offen lds
    s_mov_b32 m0, 55296
    s_nop 0
    buffer_load_dwordx4 v37, s[40:43], s90 offen lds
    s_mov_b32 m0, 56320
    s_nop 0
    buffer_load_dwordx4 v38, s[40:43], s90 offen lds
    s_add_u32 s90, s90, 26624
    s_cmp_eq_u32 s90, s72
    s_cselect_b32 s70, 346112, 0
    s_sub_u32 s90, s90, s70
    s_mov_b32 m0, 57344
    s_nop 0
    buffer_load_dwordx4 v32, s[40:43], s90 offen lds
    s_mov_b32 m0, 58368
    s_nop 0
    buffer_load_dwordx4 v33, s[40:43], s90 offen lds
    s_mov_b32 m0, 59392
    s_nop 0
    buffer_load_dwordx4 v34, s[40:43], s90 offen lds
    s_mov_b32 m0, 60416
    s_nop 0
    buffer_load_dwordx4 v35, s[40:43], s90 offen lds
    s_mov_b32 m0, 61440
    s_nop 0
    buffer_load_dwordx4 v36, s[40:43], s90 offen lds
    s_mov_b32 m0, 62464
    s_nop 0
    buffer_load_dwordx4 v37, s[40:43], s90 offen lds
    s_mov_b32 m0, 63488
    s_nop 0
    buffer_load_dwordx4 v38, s[40:43], s90 offen lds
    s_add_u32 s90, s90, 26624
    s_cmp_eq_u32 s90, s72
    s_cselect_b32 s70, 346112, 0
    s_sub_u32 s90, s90, s70
    s_waitcnt vmcnt(56)
    v_mov_b32 v23, 5
    ds_write_b32 v20, v23 offset:0
    s_mov_b32 m0, 64512
    s_nop 0
    buffer_load_dwordx4 v32, s[40:43], s90 offen lds
    s_mov_b32 m0, 65536
    s_nop 0
    buffer_load_dwordx4 v33, s[40:43], s90 offen lds
    s_mov_b32 m0, 66560
    s_nop 0
    buffer_load_dwordx4 v34, s[40:43], s90 offen lds
    s_mov_b32 m0, 67584
    s_nop 0
    buffer_load_dwordx4 v35, s[40:43], s90 offen lds
    s_mov_b32 m0, 68608
    s_nop 0
    buffer_load_dwordx4 v36, s[40:43], s90 offen lds
    s_mov_b32 m0, 69632
    s_nop 0
    buffer_load_dwordx4 v37, s[40:43], s90 offen lds
    s_mov_b32 m0, 70656
    s_nop 0
    buffer_load_dwordx4 v38, s[40:43], s90 offen lds
    s_add_u32 s90, s90, 26624
    s_cmp_eq_u32 s90, s72
    s_cselect_b32 s70, 346112, 0
    s_sub_u32 s90, s90, s70
    s_mov_b64 exec, 0x4
    buffer_load_dword v18, v19, s[60:63], 0 offen offset:128 sc1
    s_mov_b64 exec, -1
    s_waitcnt vmcnt(50)
    v_mov_b32 v23, 7
    ds_write_b32 v20, v23 offset:0
    s_waitcnt vmcnt(36)
    v_mov_b32 v23, 9
    ds_write_b32 v20, v23 offset:0
    s_waitcnt vmcnt(22)
    v_mov_b32 v23, 11
    ds_write_b32 v20, v23 offset:0
    s_waitcnt vmcnt(8)
    v_mov_b32 v23, 13
    ds_write_b32 v20, v23 offset:0
    s_waitcnt vmcnt(1)
    v_mov_b32 v23, 14
    ds_write_b32 v20, v23 offset:0
    s_waitcnt vmcnt(0)
    s_mov_b64 exec, 0x4
    s_mov_b32 s69, 0
L_pollk:
    v_cmp_eq_u32 vcc, 0, v18
    s_cbranch_vccz L_polldonek
    s_sleep 6
    buffer_load_dword v18, v19, s[60:63], 0 offen offset:128 sc1
    s_add_u32 s69, s69, 1
    s_cmp_lt_u32 s69, 0x40000
    s_waitcnt vmcnt(0)
    s_cbranch_scc1 L_pollk
L_polldonek:
    s_mov_b64 exec, -1
    s_mov_b64 exec, 0x1
    buffer_load_dword v18, v19, s[60:63], 0 offen offset:128 sc1
    s_mov_b64 exec, -1
    s_lshr_b32 s69, s2, 3
    s_mul_i32 s69, s69, 608
    s_mov_b32 exec_hi, 0x3f
    buffer_load_dwordx4 v[56:59], v31, s[64:67], s69 offen sc1
    s_mov_b64 exec, -1
    s_mov_b32 s70, 0x100000
L_dwa:
    ds_read_b32 v22, v21 offset:0
    s_sub_u32 s70, s70, 1
    s_cbranch_scc1 L_dna
    s_waitcnt lgkmcnt(0)
    v_cmp_gt_u32 vcc, 1, v22
    s_cbranch_vccz L_dna
    s_sleep 1
    s_branch L_dwa
L_dna:
    s_mov_b32 m0, 123968
    s_mov_b32 s71, 0
    buffer_load_dwordx4 v31, s[64:67], s71 offen offset:0 sc1 lds
    buffer_load_dwordx4 v31, s[64:67], s71 offen offset:1024 sc1 lds
    buffer_load_dwordx4 v31, s[64:67], s71 offen offset:2048 sc1 lds
    buffer_load_dwordx4 v31, s[64:67], s71 offen offset:3072 sc1 lds
    s_mov_b32 m0, 128064
    s_mov_b32 s71, 4096
    buffer_load_dwordx4 v31, s[64:67], s71 offen offset:0 sc1 lds
    buffer_load_dwordx4 v31, s[64:67], s71 offen offset:1024 sc1 lds
    buffer_load_dwordx4 v31, s[64:67], s71 offen offset:2048 sc1 lds
    buffer_load_dwordx4 v31, s[64:67], s71 offen offset:3072 sc1 lds
    s_mov_b32 m0, 132160
    s_mov_b32 s71, 8192
    buffer_load_dwordx4 v31, s[64:67], s71 offen offset:0 sc1 lds
    buffer_load_dwordx4 v31, s[64:67], s71 offen offset:1024 sc1 lds
    buffer_load_dwordx4 v31, s[64:67], s71 offen offset:2048 sc1 lds
    buffer_load_dwordx4 v31, s[64:67], s71 offen offset:3072 sc1 lds
    s_mov_b32 m0, 136256
    s_mov_b32 s71, 12288
    buffer_load_dwordx4 v31, s[64:67], s71 offen offset:0 sc1 lds
    buffer_load_dwordx4 v31, s[64:67], s71 offen offset:1024 sc1 lds
    buffer_load_dwordx4 v31, s[64:67], s71 offen offset:2048 sc1 lds
    buffer_load_dwordx4 v31, s[64:67], s71 offen offset:3072 sc1 lds
    s_mov_b32 m0, 140352
    s_mov_b32 s71, 16384
    buffer_load_dwordx4 v31, s[64:67], s71 offen offset:0 sc1 lds
    buffer_load_dwordx4 v31, s[64:67], s71 offen offset:1024 sc1 lds
    s_mov_b32 exec_hi, 0xfff
    buffer_load_dwordx4 v31, s[64:67], s71 offen offset:2048 sc1 lds
    s_mov_b64 exec, -1
    s_mov_b32 m0, 160768
    s_mov_b32 s71, 166400
    s_mov_b64 exec, 0xff
    buffer_load_dwordx4 v31, s[64:67], s71 offen offset:0 sc1 lds
    s_mov_b64 exec, -1
    s_waitcnt vmcnt(21)
    s_mov_b64 exec, 0x1
    s_mov_b32 s69, 0
L_polla:
    v_cmp_eq_u32 vcc, 0, v18
    s_cbranch_vccz L_polldonea
    s_sleep 6
    buffer_load_dword v18, v19, s[60:63], 0 offen offset:128 sc1
    s_add_u32 s69, s69, 1
    s_cmp_lt_u32 s69, 0x40000
    s_waitcnt vmcnt(0)
    v_mov_b32 v23, 1
    ds_write_b32 v20, v23 offset:8
    s_cbranch_scc1 L_polla
L_polldonea:
    s_mov_b64 exec, -1
    v_readlane_b32 s69, v18, 0
    s_nop 1
    v_mov_b32 v24, s69
    s_lshr_b32 s69, s2, 3
    s_mul_i32 s69, s69, 3360
    s_add_u32 s69, s69, 19200
    buffer_load_dwordx4 v[40:43], v31, s[64:67], s69 offen offset:0 sc1
    buffer_load_dwordx4 v[44:47], v31, s[64:67], s69 offen offset:1024 sc1
    buffer_load_dwordx4 v[48:51], v31, s[64:67], s69 offen offset:2048 sc1
    s_mov_b64 exec, 0x3ffff
    buffer_load_dwordx4 v[52:55], v31, s[64:67], s69 offen offset:3072 sc1
    s_mov_b64 exec, -1
    s_mov_b32 m0, 160896
    s_mov_b32 s71, 166528
    s_mov_b64 exec, 0xffffff
    buffer_load_dwordx4 v31, s[64:67], s71 offen offset:0 sc1 lds
    s_mov_b64 exec, -1
    s_mov_b32 s70, 0x100000
L_dwb:
    ds_read_b32 v22, v21 offset:0
    s_sub_u32 s70, s70, 1
    s_cbranch_scc1 L_dnb
    s_waitcnt lgkmcnt(0)
    v_cmp_gt_u32 vcc, 2, v22
    s_cbranch_vccz L_dnb
    s_waitcnt vmcnt(0)
    v_mov_b32 v23, 1
    ds_write_b32 v20, v23 offset:8
    s_sleep 1
    s_branch L_dwb
L_dnb:
    s_mov_b32 m0, 0
    s_mov_b32 s71, 19200
    buffer_load_dwordx4 v31, s[64:67], s71 offen offset:0 sc1 lds
    buffer_load_dwordx4 v31, s[64:67], s71 offen offset:1024 sc1 lds
    buffer_load_dwordx4 v31, s[64:67], s71 offen offset:2048 sc1 lds
    buffer_load_dwordx4 v31, s[64:67], s71 offen offset:3072 sc1 lds
    s_mov_b32 m0, 4096
    s_mov_b32 s71, 23296
    buffer_load_dwordx4 v31, s[64:67], s71 offen offset:0 sc1 lds
    buffer_load_dwordx4 v31, s[64:67], s71 offen offset:1024 sc1 lds
    buffer_load_dwordx4 v31, s[64:67], s71 offen offset:2048 sc1 lds
    buffer_load_dwordx4 v31, s[64:67], s71 offen offset:3072 sc1 lds
    s_mov_b32 m0, 8192
    s_mov_b32 s71, 27392
    buffer_load_dwordx4 v31, s[64:67], s71 offen offset:0 sc1 lds
    buffer_load_dwordx4 v31, s[64:67], s71 offen offset:1024 sc1 lds
    buffer_load_dwordx4 v31, s[64:67], s71 offen offset:2048 sc1 lds
    buffer_load_dwordx4 v31, s[64:67], s71 offen offset:3072 sc1 lds
    s_mov_b32 m0, 12288
    s_mov_b32 s71, 31488
    buffer_load_dwordx4 v31, s[64:67], s71 offen offset:0 sc1 lds
    buffer_load_dwordx4 v31, s[64:67], s71 offen offset:1024 sc1 lds
    buffer_load_dwordx4 v31, s[64:67], s71 offen offset:2048 sc1 lds
    buffer_load_dwordx4 v31, s[64:67], s71 offen offset:3072 sc1 lds
    s_waitcnt vmcnt(21)
    v_mov_b32 v23, 1
    ds_write_b32 v20, v23 offset:8
    s_mov_b32 m0, 16384
    s_mov_b32 s71, 35584
    buffer_load_dwordx4 v31, s[64:67], s71 offen offset:0 sc1 lds
    buffer_load_dwordx4 v31, s[64:67], s71 offen offset:1024 sc1 lds
    buffer_load_dwordx4 v31, s[64:67], s71 offen offset:2048 sc1 lds
    buffer_load_dwordx4 v31, s[64:67], s71 offen offset:3072 sc1 lds
    s_mov_b32 m0, 20480
    s_mov_b32 s71, 39680
    buffer_load_dwordx4 v31, s[64:67], s71 offen offset:0 sc1 lds
    buffer_load_dwordx4 v31, s[64:67], s71 offen offset:1024 sc1 lds
    buffer_load_dwordx4 v31, s[64:67], s71 offen offset:2048 sc1 lds
    buffer_load_dwordx4 v31, s[64:67], s71 offen offset:3072 sc1 lds
    s_mov_b32 m0, 24576
    s_mov_b32 s71, 43776
    buffer_load_dwordx4 v31, s[64:67], s71 offen offset:0 sc1 lds
    buffer_load_dwordx4 v31, s[64:67], s71 offen offset:1024 sc1 lds
    buffer_load_dwordx4 v31, s[64:67], s71 offen offset:2048 sc1 lds
    buffer_load_dwordx4 v31, s[64:67], s71 offen offset:3072 sc1 lds
    s_mov_b32 m0, 28672
    s_mov_b32 s71, 47872
    buffer_load_dwordx4 v31, s[64:67], s71 offen offset:0 sc1 lds
    buffer_load_dwordx4 v31, s[64:67], s71 offen offset:1024 sc1 lds
    buffer_load_dwordx4 v31, s[64:67], s71 offen offset:2048 sc1 lds
    buffer_load_dwordx4 v31, s[64:67], s71 offen offset:3072 sc1 lds
    s_mov_b32 m0, 32768
    s_mov_b32 s71, 51968
    buffer_load_dwordx4 v31, s[64:67], s71 offen offset:0 sc1 lds
    buffer_load_dwordx4 v31, s[64:67], s71 offen offset:1024 sc1 lds
    s_mov_b32 exec_hi, 0xfffffff
    buffer_load_dwordx4 v31, s[64:67], s71 offen offset:2048 sc1 lds
    s_mov_b64 exec, -1
    s_waitcnt vmcnt(0)
    v_mov_b32 v23, 2
    ds_write_b32 v20, v23 offset:8
    s_mov_b32 s70, 0x100000
L_dwc:
    ds_read_b32 v22, v21 offset:0
    s_sub_u32 s70, s70, 1
    s_cbranch_scc1 L_dnc
    s_waitcnt lgkmcnt(0)
    v_cmp_gt_u32 vcc, 3, v22
    s_cbranch_vccz L_dnc
    s_sleep 1
    s_branch L_dwc
L_dnc:
    s_mov_b32 m0, 35776
    s_mov_b32 s71, 54976
    buffer_load_dwordx4 v31, s[64:67], s71 offen offset:0 sc1 lds
    buffer_load_dwordx4 v31, s[64:67], s71 offen offset:1024 sc1 lds
    buffer_load_dwordx4 v31, s[64:67], s71 offen offset:2048 sc1 lds
    buffer_load_dwordx4 v31, s[64:67], s71 offen offset:3072 sc1 lds
    s_mov_b32 m0, 39872
    s_mov_b32 s71, 59072
    buffer_load_dwordx4 v31, s[64:67], s71 offen offset:0 sc1 lds
    buffer_load_dwordx4 v31, s[64:67], s71 offen offset:1024 sc1 lds
    buffer_load_dwordx4 v31, s[64:67], s71 offen offset:2048 sc1 lds
    buffer_load_dwordx4 v31, s[64:67], s71 offen offset:3072 sc1 lds
    s_mov_b32 m0, 43968
    s_mov_b32 s71, 63168
    buffer_load_dwordx4 v31, s[64:67], s71 offen offset:0 sc1 lds
    buffer_load_dwordx4 v31, s[64:67], s71 offen offset:1024 sc1 lds
    buffer_load_dwordx4 v31, s[64:67], s71 offen offset:2048 sc1 lds
    buffer_load_dwordx4 v31, s[64:67], s71 offen offset:3072 sc1 lds
    s_mov_b32 m0, 48064
    s_mov_b32 s71, 67264
    buffer_load_dwordx4 v31, s[64:67], s71 offen offset:0 sc1 lds
    buffer_load_dwordx4 v31, s[64:67], s71 offen offset:1024 sc1 lds
    buffer_load_dwordx4 v31, s[64:67], s71 offen offset:2048 sc1 lds
    buffer_load_dwordx4 v31, s[64:67], s71 offen offset:3072 sc1 lds
    s_mov_b32 m0, 52160
    s_mov_b32 s71, 71360
    buffer_load_dwordx4 v31, s[64:67], s71 offen offset:0 sc1 lds
    buffer_load_dwordx4 v31, s[64:67], s71 offen offset:1024 sc1 lds
    buffer_load_dwordx4 v31, s[64:67], s71 offen offset:2048 sc1 lds
    buffer_load_dwordx4 v31, s[64:67], s71 offen offset:3072 sc1 lds
    s_mov_b32 m0, 56256
    s_mov_b32 s71, 75456
    buffer_load_dwordx4 v31, s[64:67], s71 offen offset:0 sc1 lds
    buffer_load_dwordx4 v31, s[64:67], s71 offen offset:1024 sc1 lds
    buffer_load_dwordx4 v31, s[64:67], s71 offen offset:2048 sc1 lds
    buffer_load_dwordx4 v31, s[64:67], s71 offen offset:3072 sc1 lds
    s_mov_b32 m0, 60352
    s_mov_b32 s71, 79552
    buffer_load_dwordx4 v31, s[64:67], s71 offen offset:0 sc1 lds
    buffer_load_dwordx4 v31, s[64:67], s71 offen offset:1024 sc1 lds
    buffer_load_dwordx4 v31, s[64:67], s71 offen offset:2048 sc1 lds
    buffer_load_dwordx4 v31, s[64:67], s71 offen offset:3072 sc1 lds
    s_mov_b32 m0, 64448
    s_mov_b32 s71, 83648
    buffer_load_dwordx4 v31, s[64:67], s71 offen offset:0 sc1 lds
    buffer_load_dwordx4 v31, s[64:67], s71 offen offset:1024 sc1 lds
    buffer_load_dwordx4 v31, s[64:67], s71 offen offset:2048 sc1 lds
    buffer_load_dwordx4 v31, s[64:67], s71 offen offset:3072 sc1 lds
    s_mov_b32 m0, 68544
    s_mov_b32 s71, 87744
    buffer_load_dwordx4 v31, s[64:67], s71 offen offset:0 sc1 lds
    buffer_load_dwordx4 v31, s[64:67], s71 offen offset:1024 sc1 lds
    s_mov_b32 exec_hi, 0xfffffff
    buffer_load_dwordx4 v31, s[64:67], s71 offen offset:2048 sc1 lds
    s_mov_b64 exec, -1
    s_mov_b32 m0, 71552
    s_mov_b32 s71, 90752
    buffer_load_dwordx4 v31, s[64:67], s71 offen offset:0 sc1 lds
    buffer_load_dwordx4 v31, s[64:67], s71 offen offset:1024 sc1 lds
    buffer_load_dwordx4 v31, s[64:67], s71 offen offset:2048 sc1 lds
    buffer_load_dwordx4 v31, s[64:67], s71 offen offset:3072 sc1 lds
    s_mov_b32 m0, 75648
    s_mov_b32 s71, 94848
    buffer_load_dwordx4 v31, s[64:67], s71 offen offset:0 sc1 lds
    buffer_load_dwordx4 v31, s[64:67], s71 offen offset:1024 sc1 lds
    buffer_load_dwordx4 v31, s[64:67], s71 offen offset:2048 sc1 lds
    buffer_load_dwordx4 v31, s[64:67], s71 offen offset:3072 sc1 lds
    s_mov_b32 m0, 79744
    s_mov_b32 s71, 98944
    buffer_load_dwordx4 v31, s[64:67], s71 offen offset:0 sc1 lds
    buffer_load_dwordx4 v31, s[64:67], s71 offen offset:1024 sc1 lds
    buffer_load_dwordx4 v31, s[64:67], s71 offen offset:2048 sc1 lds
    buffer_load_dwordx4 v31, s[64:67], s71 offen offset:3072 sc1 lds
    s_mov_b32 m0, 83840
    s_mov_b32 s71, 103040
    buffer_load_dwordx4 v31, s[64:67], s71 offen offset:0 sc1 lds
    buffer_load_dwordx4 v31, s[64:67], s71 offen offset:1024 sc1 lds
    buffer_load_dwordx4 v31, s[64:67], s71 offen offset:2048 sc1 lds
    buffer_load_dwordx4 v31, s[64:67], s71 offen offset:3072 sc1 lds
    s_mov_b32 m0, 87936
    s_mov_b32 s71, 107136
    buffer_load_dwordx4 v31, s[64:67], s71 offen offset:0 sc1 lds
    buffer_load_dwordx4 v31, s[64:67], s71 offen offset:1024 sc1 lds
    buffer_load_dwordx4 v31, s[64:67], s71 offen offset:2048 sc1 lds
    buffer_load_dwordx4 v31, s[64:67], s71 offen offset:3072 sc1 lds
    s_mov_b32 m0, 92032
    s_mov_b32 s71, 111232
    buffer_load_dwordx4 v31, s[64:67], s71 offen offset:0 sc1 lds
    buffer_load_dwordx4 v31, s[64:67], s71 offen offset:1024 sc1 lds
    buffer_load_dwordx4 v31, s[64:67], s71 offen offset:2048 sc1 lds
    buffer_load_dwordx4 v31, s[64:67], s71 offen offset:3072 sc1 lds
    s_mov_b32 m0, 96128
    s_mov_b32 s71, 115328
    buffer_load_dwordx4 v31, s[64:67], s71 offen offset:0 sc1 lds
    buffer_load_dwordx4 v31, s[64:67], s71 offen offset:1024 sc1 lds
    buffer_load_dwordx4 v31, s[64:67], s71 offen offset:2048 sc1 lds
    buffer_load_dwordx4 v31, s[64:67], s71 offen offset:3072 sc1 lds
    s_mov_b32 m0, 100224
    s_mov_b32 s71, 119424
    buffer_load_dwordx4 v31, s[64:67], s71 offen offset:0 sc1 lds
    buffer_load_dwordx4 v31, s[64:67], s71 offen offset:1024 sc1 lds
    buffer_load_dwordx4 v31, s[64:67], s71 offen offset:2048 sc1 lds
    buffer_load_dwordx4 v31, s[64:67], s71 offen offset:3072 sc1 lds
    s_mov_b32 m0, 104320
    s_mov_b32 s71, 123520
    buffer_load_dwordx4 v31, s[64:67], s71 offen offset:0 sc1 lds
    buffer_load_dwordx4 v31, s[64:67], s71 offen offset:1024 sc1 lds
    s_mov_b32 exec_hi, 0xfffffff
    buffer_load_dwordx4 v31, s[64:67], s71 offen offset:2048 sc1 lds
    s_mov_b64 exec, -1
    s_waitcnt vmcnt(35)
    v_mov_b32 v23, 3
    ds_write_b32 v20, v23 offset:8
    s_waitcnt vmcnt(0)
    v_mov_b32 v23, 4
    ds_write_b32 v20, v23 offset:8
    s_mov_b32 s70, 0x100000
L_dwd:
    ds_read_b32 v22, v20 offset:4
    s_sub_u32 s70, s70, 1
    s_cbranch_scc1 L_dnd
    s_waitcnt lgkmcnt(0)
    v_cmp_gt_u32 vcc, 4, v22
    s_cbranch_vccz L_dnd
    s_sleep 1
    s_branch L_dwd
L_dnd:
    v_lshlrev_b32 v2, 3, v1
    v_add_u32 v2, 156672, v2
    ds_read_b64 v[68:69], v2
    v_bfe_u32 v3, v1, 3, 2
    v_add_u32 v3, s79, v3
    v_and_b32 v3, 3, v3
    v_lshlrev_b32 v3, 13, v3
    v_and_b32 v4, 7, v1
    v_lshl_add_u32 v3, v4, 4, v3
    s_lshl_b32 s69, s87, 10
    s_lshl_b32 s70, s79, 7
    s_add_u32 s69, s69, s70
    s_add_u32 s69, s69, 262144
    s_waitcnt lgkmcnt(0)
    v_mov_b32 v64, v68
    v_mov_b32 v65, v24
    v_mov_b32 v66, v69
    v_mov_b32 v67, v24
    s_mov_b64 exec, 0xffffffff
    buffer_store_dwordx4 v[64:67], v3, s[64:67], s69 offen sc1
    s_mov_b64 exec, -1
    s_mov_b32 m0, 156672
    s_mov_b32 s71, 162304
    buffer_load_dwordx4 v31, s[64:67], s71 offen offset:0 sc1 lds
    buffer_load_dwordx4 v31, s[64:67], s71 offen offset:1024 sc1 lds
    buffer_load_dwordx4 v31, s[64:67], s71 offen offset:2048 sc1 lds
    buffer_load_dwordx4 v31, s[64:67], s71 offen offset:3072 sc1 lds
    s_mov_b64 exec, 0x10000
    buffer_load_dword v18, v19, s[60:63], 0 offen offset:128 sc1
    s_mov_b64 exec, -1
    s_waitcnt vmcnt(1)
    v_mov_b32 v23, 5
    ds_write_b32 v20, v23 offset:8
    s_mov_b32 s70, 0x100000
L_dwe:
    ds_read_b32 v22, v21 offset:0
    s_sub_u32 s70, s70, 1
    s_cbranch_scc1 L_dne
    s_waitcnt lgkmcnt(0)
    v_cmp_gt_u32 vcc, 4, v22
    s_cbranch_vccz L_dne
    s_sleep 1
    s_branch L_dwe
L_dne:
    s_waitcnt vmcnt(0)
    s_mov_b64 exec, 0x10000
    s_mov_b32 s69, 0
L_pollb:
    v_cmp_eq_u32 vcc, 0, v18
    s_cbranch_vccz L_polldoneb
    s_sleep 6
    buffer_load_dword v18, v19, s[60:63], 0 offen offset:128 sc1
    s_add_u32 s69, s69, 1
    s_cmp_lt_u32 s69, 0x40000
    s_waitcnt vmcnt(0)
    s_cbranch_scc1 L_pollb
L_polldoneb:
    s_mov_b64 exec, -1
    s_mov_b32 m0, 123968
    s_mov_b32 s71, 126528
    buffer_load_dwordx4 v31, s[64:67], s71 offen offset:0 sc1 lds
    buffer_load_dwordx4 v31, s[64:67], s71 offen offset:1024 sc1 lds
    buffer_load_dwordx4 v31, s[64:67], s71 offen offset:2048 sc1 lds
    buffer_load_dwordx4 v31, s[64:67], s71 offen offset:3072 sc1 lds
    s_mov_b32 m0, 128064
    s_mov_b32 s71, 130624
    buffer_load_dwordx4 v31, s[64:67], s71 offen offset:0 sc1 lds
    buffer_load_dwordx4 v31, s[64:67], s71 offen offset:1024 sc1 lds
    buffer_load_dwordx4 v31, s[64:67], s71 offen offset:2048 sc1 lds
    buffer_load_dwordx4 v31, s[64:67], s71 offen offset:3072 sc1 lds
    s_mov_b32 m0, 132160
    s_mov_b32 s71, 134720
    buffer_load_dwordx4 v31, s[64:67], s71 offen offset:0 sc1 lds
    buffer_load_dwordx4 v31, s[64:67], s71 offen offset:1024 sc1 lds
    buffer_load_dwordx4 v31, s[64:67], s71 offen offset:2048 sc1 lds
    buffer_load_dwordx4 v31, s[64:67], s71 offen offset:3072 sc1 lds
    s_mov_b32 m0, 136256
    s_mov_b32 s71, 138816
    buffer_load_dwordx4 v31, s[64:67], s71 offen offset:0 sc1 lds
    buffer_load_dwordx4 v31, s[64:67], s71 offen offset:1024 sc1 lds
    buffer_load_dwordx4 v31, s[64:67], s71 offen offset:2048 sc1 lds
    buffer_load_dwordx4 v31, s[64:67], s71 offen offset:3072 sc1 lds
    s_mov_b32 m0, 140352
    s_mov_b32 s71, 142912
    buffer_load_dwordx4 v31, s[64:67], s71 offen offset:0 sc1 lds
    buffer_load_dwordx4 v31, s[64:67], s71 offen offset:1024 sc1 lds
    s_mov_b32 exec_hi, 0xfff
    buffer_load_dwordx4 v31, s[64:67], s71 offen offset:2048 sc1 lds
    s_mov_b64 exec, -1
    s_mov_b32 m0, 161280
    s_mov_b32 s71, 166912
    s_mov_b64 exec, 0xff
    buffer_load_dwordx4 v31, s[64:67], s71 offen offset:0 sc1 lds
    s_mov_b64 exec, -1
    s_waitcnt vmcnt(0)
    v_mov_b32 v23, 6
    ds_write_b32 v20, v23 offset:8
    s_lshl_b32 s71, s2, 10
    s_add_u32 s71, s71, 262144
    s_mov_b32 s69, 0
    s_mov_b64 exec, 0xffffffff
L_inb:
    buffer_load_dwordx4 v[72:75], v31, s[64:67], s71 offen sc1
    s_add_u32 s69, s69, 1
    s_waitcnt vmcnt(0)
    v_cmp_ne_u32 vcc, v24, v73
    v_cmp_ne_u32 s[84:85], v24, v75
    s_nop 1
    s_or_b64 vcc, vcc, s[84:85]
    s_cbranch_vccz L_inbok
    s_sleep 6
    s_cmp_lt_u32 s69, 0x40000
    s_cbranch_scc1 L_inb
L_inbok:
    v_mov_b32 v73, v74
    v_lshlrev_b32 v2, 3, v1
    v_add_u32 v2, 162048, v2
    ds_write_b64 v2, v[72:73]
    v_mov_b32 v23, 7
    ds_write_b32 v20, v23 offset:8
L_end:
    s_endpgm
.section .rodata,"a"
.p2align 6
.amdhsa_kernel standalone__deep_cross_xdeepfm__recsys_kernel
  .amdhsa_next_free_vgpr 168
  .amdhsa_next_free_sgpr 102
  .amdhsa_accum_offset 168
  .amdhsa_group_segment_fixed_size 0
  .amdhsa_kernarg_size 88
  .amdhsa_user_sgpr_count 2
  .amdhsa_user_sgpr_kernarg_segment_ptr 1
  .amdhsa_system_sgpr_workgroup_id_x 1
  .amdhsa_float_denorm_mode_32 3
.end_amdhsa_kernel
```
